```python
import torch

def _softmax(x, axis=-1):
    return torch.softmax(x, dim=axis)
def _gelu(x):
    return torch.nn.functional.gelu(x, approximate="tanh")
def _silu(x):
    return torch.nn.functional.silu(x)
def _sigmoid(x):
    return torch.sigmoid(x)
def _layernorm(x, axis=-1, eps=1e-5):
    m = x.mean(dim=axis, keepdim=True)
    v = x.var(dim=axis, keepdim=True, unbiased=False)
    return (x - m) / torch.sqrt(v + eps)
def _scatter_add(tgt, idx, src, axis=0):
    return tgt.clone().index_add_(axis, idx, src)
def _segment_sum(src, seg, n):
    out = torch.zeros((n,) + src.shape[1:], dtype=src.dtype)
    return out.index_add_(0, seg, src)
def _pad(x, pw):
    flat = tuple(v for pair in reversed(pw) for v in pair)
    return torch.nn.functional.pad(x, flat)

kernel_name = 'interleave_layers__sliding_local_dilated__sliding_local_dilated__prompt'

def setup_inputs():

    _w = (lambda a: (lambda t: t.to(torch.bfloat16) if t.is_floating_point() else t)(torch.as_tensor(a)))
    def _A_setup():
        B, S, D = 1, 2048, 576
        return {
            "x": _w((lambda *s: torch.randn(*s, dtype=torch.bfloat16) * 0.05)(B, S, D)),
            "wqkv": _w((lambda *s: torch.randn(*s, dtype=torch.bfloat16) * 0.05)(D, 3 * D)),
            "wo": _w((lambda *s: torch.randn(*s, dtype=torch.bfloat16) * 0.05)(D, D)),
        }
    _A_in = _A_setup()

    def _B_setup():
        B, S, D = 1, 2048, 576
        return {
            "x": _w((lambda *s: torch.randn(*s, dtype=torch.bfloat16) * 0.05)(B, S, D)),
            "wqkv": _w((lambda *s: torch.randn(*s, dtype=torch.bfloat16) * 0.05)(D, 3 * D)),
            "wo": _w((lambda *s: torch.randn(*s, dtype=torch.bfloat16) * 0.05)(D, D)),
        }
    _B_in = _B_setup()

    return {
        "A_x": _A_in["x"],
        "A_wqkv": _A_in["wqkv"],
        "A_wo": _A_in["wo"],
        "B_x": _B_in["x"],
        "B_wqkv": _B_in["wqkv"],
        "B_wo": _B_in["wo"],
    }

def reference(A_x, A_wqkv, A_wo, B_x, B_wqkv, B_wo):
    def _A_ref(x, wqkv, wo):
        B, S, D = x.shape
        H = 32; Dh = D // H
        W, dil = 8, 2
        qkv = (lambda x, *d: x.permute(*d))((x @ wqkv).reshape(B, S, 3, H, Dh), 2, 0, 3, 1, 4)
        q, k, v = qkv[0], qkv[1], qkv[2]
        scale = Dh ** -0.5
        pos = torch.arange(S)
        off = torch.arange(W) * dil
        idx = pos[:, None] - off[None, :]
        mask = idx >= 0
        idx_c = torch.where(mask, idx, 0).reshape(-1)
        kg = k[:, :, idx_c, :].reshape(B, H, S, W, Dh)
        vg = v[:, :, idx_c, :].reshape(B, H, S, W, Dh)
        logits = torch.einsum("bhsd,bhswd->bhsw", q, kg) * scale
        logits = torch.where(mask[None, None, :, :], logits, -1e9)
        attn = _softmax(logits, axis=-1)
        o = torch.einsum("bhsw,bhswd->bhsd", attn, vg)
        return (lambda x, *d: x.permute(*d))(o, 0, 2, 1, 3).reshape(B, S, D) @ wo

    def _B_ref(x, wqkv, wo):
        B, S, D = x.shape
        H = 32; Dh = D // H
        W, dil = 8, 2
        qkv = (lambda x, *d: x.permute(*d))((x @ wqkv).reshape(B, S, 3, H, Dh), 2, 0, 3, 1, 4)
        q, k, v = qkv[0], qkv[1], qkv[2]
        scale = Dh ** -0.5
        pos = torch.arange(S)
        off = torch.arange(W) * dil
        idx = pos[:, None] - off[None, :]
        mask = idx >= 0
        idx_c = torch.where(mask, idx, 0).reshape(-1)
        kg = k[:, :, idx_c, :].reshape(B, H, S, W, Dh)
        vg = v[:, :, idx_c, :].reshape(B, H, S, W, Dh)
        logits = torch.einsum("bhsd,bhswd->bhsw", q, kg) * scale
        logits = torch.where(mask[None, None, :, :], logits, -1e9)
        attn = _softmax(logits, axis=-1)
        o = torch.einsum("bhsw,bhswd->bhsd", attn, vg)
        return (lambda x, *d: x.permute(*d))(o, 0, 2, 1, 3).reshape(B, S, D) @ wo

    x = A_x
    x = x + _A_ref(_layernorm(x, axis=-1), A_wqkv, A_wo)
    x = x + _B_ref(_layernorm(x, axis=-1), B_wqkv, B_wo)
    x = x + _A_ref(_layernorm(x, axis=-1), A_wqkv, A_wo)
    x = x + _B_ref(_layernorm(x, axis=-1), B_wqkv, B_wo)
    return x
```

```asm
; @launch grid=(256,1,1) block=(512,1,1) lds=162560
.amdgcn_target "amdgcn-amd-amdhsa--gfx950"
.text
.globl interleave_layers__sliding_local_dilated__sliding_local_dilated__prompt_kernel
.p2align 8
.type interleave_layers__sliding_local_dilated__sliding_local_dilated__prompt_kernel,@function
interleave_layers__sliding_local_dilated__sliding_local_dilated__prompt_kernel:
    s_cmp_ge_u32 s2, 256
    s_cbranch_scc1 L_END
    s_load_dwordx16 s[4:19], s[0:1], 0
    s_load_dwordx2 s[20:21], s[0:1], 64
    v_and_b32 v103, 63, v0
    v_lshrrev_b32 v1, 6, v0
    s_nop 0
    v_readfirstlane_b32 s48, v1
    s_getreg_b32 s93, hwreg(HW_REG_XCC_ID)
    s_and_b32 s93, s93, 15
    s_and_b32 s49, s48, 3
    s_lshr_b32 s50, s48, 2
    s_and_b32 s60, s2, 7
    s_lshr_b32 s61, s2, 3
    s_and_b32 s52, s61, 15
    s_lshr_b32 s61, s61, 4
    s_lshl_b32 s51, s60, 1
    s_add_u32 s51, s51, s61
    s_mov_b32 s56, 0x1e8480
    s_mov_b32 s72, 0x05040100
    s_mov_b32 s73, 0x07060302
    s_mov_b32 s53, 0
    s_mov_b32 s94, 0
    s_mov_b32 s85, 0
    v_mov_b32 v102, 0x22840
    v_and_b32 v1, 3, v103
    v_cmp_eq_u32 s[74:75], 1, v1
    v_cmp_eq_u32 s[76:77], 2, v1
    v_cmp_eq_u32 s[78:79], 3, v1
    v_lshrrev_b32 v1, 4, v103
    v_bfe_u32 v2, v103, 2, 2
    v_cmp_eq_u32 s[80:81], v1, v2
    v_mov_b32 v1, 0
    v_lshl_add_u32 v2, v103, 2, v102
    ds_write_b32 v2, v1
    s_waitcnt lgkmcnt(0)
    s_mov_b32 s24, s4
    s_and_b32 s25, s5, 0xffff
    s_mov_b32 s26, 0x240000
    s_mov_b32 s27, 0x00020000
    s_mov_b32 s36, s16
    s_and_b32 s37, s17, 0xffff
    s_mov_b32 s38, 0x240000
    s_mov_b32 s39, 0x00020000
    s_mov_b32 s44, s18
    s_and_b32 s45, s19, 0xffff
    s_mov_b32 s46, 0x100
    s_mov_b32 s47, 0x00020000
    s_mov_b32 s88, s20
    s_and_b32 s89, s21, 0xffff
    s_mov_b32 s90, 0x5000000
    s_mov_b32 s91, 0x00020000
    s_add_u32 s20, s20, 0x100000
    s_addc_u32 s21, s21, 0
    s_mov_b32 s40, s20
    s_and_b32 s41, s21, 0xffff
    s_mov_b32 s42, 0x5000000
    s_mov_b32 s43, 0x00020000
    s_mov_b32 s92, 0
    s_cmp_eq_u32 s50, 0
    s_cbranch_scc0 L_SETB_SRD
    s_mov_b32 s28, s6
    s_and_b32 s29, s7, 0xffff
    s_mov_b32 s30, 0x1e6000
    s_mov_b32 s31, 0x00020000
    s_mov_b32 s32, s14
    s_and_b32 s33, s15, 0xffff
    s_mov_b32 s34, 0xa2000
    s_mov_b32 s35, 0x00020000
    s_branch L_SRD_DONE
L_SETB_SRD:
    s_mov_b32 s28, s12
    s_and_b32 s29, s13, 0xffff
    s_mov_b32 s30, 0x1e6000
    s_mov_b32 s31, 0x00020000
    s_mov_b32 s32, s8
    s_and_b32 s33, s9, 0xffff
    s_mov_b32 s34, 0xa2000
    s_mov_b32 s35, 0x00020000
L_SRD_DONE:
    s_mul_i32 s4, s49, 19456
    s_mul_i32 s95, s51, 155648
    s_mul_i32 s60, s49, 19456
    s_add_u32 s95, s95, s60
    s_lshl_b32 s12, s51, 11
    s_lshl_b32 s60, s49, 7
    s_add_u32 s12, s12, s60
    s_add_u32 s12, s12, 21233664
    s_mov_b32 s13, 0
    s_mov_b32 s15, 0
    s_mov_b32 s7, 0
    s_mul_i32 s8, s49, 5120
    s_add_u32 s8, s8, 0x22940
    s_mov_b32 s14, s50
    s_mul_i32 s16, s49, 48
    s_add_u32 s16, s16, 0x13000
    s_lshl_b32 s17, s49, 4
    s_add_u32 s17, s17, 0x13090
    s_lshl_b32 s18, s49, 6
    s_add_u32 s18, s18, 0x22680
    s_mov_b32 s19, 0x22640
    s_and_b32 s22, s51, 1
    s_mov_b32 s20, 0xfedcfedc
    s_mov_b32 s21, 0xfedcfedc
    s_setprio 2
    s_barrier
    s_cmp_eq_u32 s50, 0
    s_cbranch_scc0 L_H0
    v_and_b32 v2, 15, v103
    v_lshrrev_b32 v3, 4, v103
    v_lshrrev_b32 v4, 2, v2
    v_and_b32 v5, 3, v2
    s_mul_i32 s60, s49, 3
    v_add_u32 v6, s60, v4
    v_lshrrev_b32 v0, 2, v6
    v_mul_u32_u24 v0, 576, v0
    v_bfe_u32 v7, v6, 1, 1
    v_mul_u32_u24 v7, 18, v7
    v_add_u32 v0, v0, v7
    v_and_b32 v7, 1, v6
    v_lshl_add_u32 v0, v7, 3, v0
    v_lshl_add_u32 v0, v5, 1, v0
    s_mul_i32 s60, s49, 576
    s_add_u32 s60, s60, 16
    v_mul_u32_u24 v7, 18, v5
    v_add_u32 v7, s60, v7
    v_cmp_eq_u32 vcc, 3, v4
    s_nop 1
    v_cndmask_b32 v0, v0, v7, vcc
    s_mul_i32 s60, s52, 36
    v_add_u32 v0, s60, v0
    v_lshlrev_b32 v0, 1, v0
    s_cmp_eq_u32 s49, 3
    s_cselect_b32 s60, 12, 14
    v_cmp_le_u32 vcc, s60, v2
    v_mov_b32 v7, 0x7f000000
    s_nop 0
    v_cndmask_b32 v0, v0, v7, vcc
    s_mov_b32 s60, 248832
    v_mul_lo_u32 v7, v3, s60
    v_add_u32 v1, v0, v7
    v_mul_u32_u24 v7, 27648, v3
    v_add_u32 v0, v0, v7
    s_mul_i32 s62, s51, 124416
    s_and_b32 s63, s51, 1
    s_mul_i32 s63, s63, 995328
    s_add_u32 s60, s62, 0
    buffer_load_dword v112, v0, s[28:31], s60 offen
    buffer_load_dword v116, v0, s[28:31], s60 offen offset:3456
    s_add_u32 s61, s62, 6912
    buffer_load_dword v113, v0, s[28:31], s61 offen
    buffer_load_dword v117, v0, s[28:31], s61 offen offset:3456
    s_add_u32 s60, s62, 13824
    buffer_load_dword v114, v0, s[28:31], s60 offen
    buffer_load_dword v118, v0, s[28:31], s60 offen offset:3456
    s_add_u32 s61, s62, 20736
    buffer_load_dword v115, v0, s[28:31], s61 offen
    buffer_load_dword v119, v0, s[28:31], s61 offen offset:3456
    s_add_u32 s60, s63, 110592
    buffer_load_dword v120, v1, s[28:31], s60 offen
    buffer_load_dword v124, v1, s[28:31], s60 offen offset:3456
    s_add_u32 s61, s63, 117504
    buffer_load_dword v121, v1, s[28:31], s61 offen
    buffer_load_dword v125, v1, s[28:31], s61 offen offset:3456
    s_add_u32 s60, s63, 235008
    buffer_load_dword v122, v1, s[28:31], s60 offen
    buffer_load_dword v126, v1, s[28:31], s60 offen offset:3456
    s_add_u32 s61, s63, 241920
    buffer_load_dword v123, v1, s[28:31], s61 offen
    buffer_load_dword v127, v1, s[28:31], s61 offen offset:3456
    v_and_b32 v24, 15, v103
    v_lshrrev_b32 v25, 4, v103
    v_lshrrev_b32 v26, 1, v25
    v_mul_u32_u24 v26, 18, v26
    v_and_b32 v27, 1, v25
    v_lshl_add_u32 v26, v27, 3, v26
    v_mul_u32_u24 v27, 72, v25
    s_cmp_ge_u32 s49, 2
    s_cselect_b64 vcc, -1, 0
    v_cndmask_b32 v26, v26, v27, vcc
    v_mul_u32_u24 v28, 1152, v26
    v_lshlrev_b32 v26, 2, v24
    v_and_b32 v27, 2, v24
    v_lshlrev_b32 v27, 1, v27
    v_add_u32 v27, 64, v27
    s_and_b32 s60, s49, 1
    s_cmp_eq_u32 s60, 1
    s_cselect_b64 vcc, -1, 0
    v_cndmask_b32 v26, v26, v27, vcc
    s_mul_i32 s60, s52, 72
    v_add3_u32 v28, v28, v26, s60
    v_and_b32 v26, 1, v24
    v_cmp_eq_u32 vcc, 1, v26
    v_mov_b32 v26, s72
    v_mov_b32 v27, s73
    v_cndmask_b32 v29, v26, v27, vcc
    s_mul_i32 s62, s51, 41472
    s_and_b32 s63, s51, 1
    s_mul_i32 s63, s63, 331776
    s_cmp_ge_u32 s49, 2
    s_cselect_b32 s60, s63, s62
    s_mov_b32 s64, 0
    s_mov_b32 s65, 18432
    s_cselect_b32 s61, s65, s64
    s_add_u32 s66, s60, s61
    buffer_load_dword v16, v28, s[32:35], s66 offen
    buffer_load_dword v20, v28, s[32:35], s66 offen offset:1152
    s_cmp_ge_u32 s49, 2
    s_cselect_b32 s60, s63, s62
    s_mov_b32 s64, 2304
    s_mov_b32 s65, 39168
    s_cselect_b32 s61, s65, s64
    s_add_u32 s67, s60, s61
    buffer_load_dword v17, v28, s[32:35], s67 offen
    buffer_load_dword v21, v28, s[32:35], s67 offen offset:1152
    s_cmp_ge_u32 s49, 2
    s_cselect_b32 s60, s63, s62
    s_mov_b32 s64, 4608
    s_mov_b32 s65, 59904
    s_cselect_b32 s61, s65, s64
    s_add_u32 s66, s60, s61
    buffer_load_dword v18, v28, s[32:35], s66 offen
    buffer_load_dword v22, v28, s[32:35], s66 offen offset:1152
    s_cmp_ge_u32 s49, 2
    s_cselect_b32 s60, s63, s62
    s_mov_b32 s64, 6912
    s_mov_b32 s65, 80640
    s_cselect_b32 s61, s65, s64
    s_add_u32 s67, s60, s61
    buffer_load_dword v19, v28, s[32:35], s67 offen
    buffer_load_dword v23, v28, s[32:35], s67 offen offset:1152
    s_cmp_ge_u32 s49, 2
    v_lshlrev_b32 v32, 4, v103
    s_mul_i32 s60, s49, 576
    v_add_u32 v32, s60, v32
    v_mov_b32 v34, -1
    v_mov_b32 v35, -1
    v_mov_b32 v36, -1
    v_mov_b32 v37, -1
    s_mov_b32 s54, 0
    s_lshl_b32 s62, s50, 5
    s_lshl_b32 s61, s51, 1
    s_add_u32 s62, s62, s61
    s_add_u32 s62, s62, s54
    s_lshl_b32 s62, s62, 4
    s_add_u32 s62, s62, s52
    s_mul_i32 s62, s62, 2304
    s_add_u32 s62, s62, 14155776
    s_mov_b32 exec_lo, -1
    s_mov_b32 exec_hi, 15
    s_add_u32 s63, s62, 0
    buffer_store_dwordx4 v[34:37], v32, s[40:43], s63 offen sc1
    s_add_u32 s63, s62, 36864
    buffer_store_dwordx4 v[34:37], v32, s[40:43], s63 offen sc1
    s_add_u32 s63, s62, 2359296
    buffer_store_dwordx4 v[34:37], v32, s[40:43], s63 offen sc1
    s_add_u32 s63, s62, 2396160
    buffer_store_dwordx4 v[34:37], v32, s[40:43], s63 offen sc1
    s_mov_b64 exec, -1
    s_waitcnt vmcnt(12)
    v_and_b32 v3, 15, v103
    v_cmp_eq_u32 vcc, 14, v3
    v_mov_b32 v3, 0x3f803f80
    s_nop 0
    v_cndmask_b32 v2, 0, v3, vcc
    v_perm_b32 v4, v116, v112, s72
    v_perm_b32 v116, v116, v112, s73
    v_or_b32 v112, v2, v4
    v_perm_b32 v5, v117, v113, s72
    v_perm_b32 v117, v117, v113, s73
    v_or_b32 v113, v2, v5
    v_perm_b32 v4, v118, v114, s72
    v_perm_b32 v118, v118, v114, s73
    v_or_b32 v114, v2, v4
    v_perm_b32 v5, v119, v115, s72
    v_perm_b32 v119, v119, v115, s73
    v_or_b32 v115, v2, v5
    v_perm_b32 v4, v124, v120, s72
    v_perm_b32 v124, v124, v120, s73
    v_or_b32 v120, v2, v4
    v_perm_b32 v5, v125, v121, s72
    v_perm_b32 v125, v125, v121, s73
    v_or_b32 v121, v2, v5
    v_perm_b32 v4, v126, v122, s72
    v_perm_b32 v126, v126, v122, s73
    v_or_b32 v122, v2, v4
    v_perm_b32 v5, v127, v123, s72
    v_perm_b32 v127, v127, v123, s73
    v_or_b32 v123, v2, v5
    s_lshl_b32 s62, s50, 4
    s_add_u32 s62, s62, s52
    s_lshl_b32 s62, s62, 2
    s_add_u32 s62, s62, s49
    s_mul_i32 s62, s62, 36864
    s_add_u32 s62, s62, 25952256
    s_lshl_b32 s63, s51, 11
    s_add_u32 s63, s63, s62
    v_lshlrev_b32 v6, 4, v103
    buffer_store_dwordx4 v[112:115], v6, s[40:43], s63 offen sc1
    buffer_store_dwordx4 v[116:119], v6, s[40:43], s63 offen offset:1024 sc1
    s_cmp_ge_u32 s51, 2
    s_nop 0
    s_cbranch_scc1 Lcs_1
    s_add_u32 s63, s63, 32768
    buffer_store_dwordx4 v[120:123], v6, s[40:43], s63 offen sc1
    buffer_store_dwordx4 v[124:127], v6, s[40:43], s63 offen offset:1024 sc1
    s_nop 1
Lcs_1:
    s_waitcnt vmcnt(2)
    s_lshr_b32 s60, s49, 1
    s_lshr_b32 s61, s51, 1
    s_min_u32 s60, s60, s61
    s_cmp_lg_u32 s60, 0
    s_cbranch_scc1 Lwus_2
    s_lshl_b32 s62, s50, 4
    s_add_u32 s62, s62, s52
    s_and_b32 s63, s51, 1
    s_add_u32 s63, s63, 16
    s_cmp_ge_u32 s49, 2
    s_cselect_b32 s63, s63, s51
    s_mul_i32 s62, s62, 41984
    s_mul_i32 s63, s63, 2304
    s_add_u32 s62, s62, s63
    s_add_u32 s62, s62, 30670848
    s_and_b32 s60, s49, 1
    s_cmp_eq_u32 s60, 1
    s_cbranch_scc1 Lwuk_3
    v_perm_b32 v24, v20, v16, s72
    v_perm_b32 v20, v20, v16, s73
    v_mov_b32 v16, v24
    v_perm_b32 v25, v21, v17, s72
    v_perm_b32 v21, v21, v17, s73
    v_mov_b32 v17, v25
    v_perm_b32 v24, v22, v18, s72
    v_perm_b32 v22, v22, v18, s73
    v_mov_b32 v18, v24
    v_perm_b32 v25, v23, v19, s72
    v_perm_b32 v23, v23, v19, s73
    v_mov_b32 v19, v25
    v_lshlrev_b32 v24, 4, v103
    buffer_store_dwordx4 v[16:19], v24, s[40:43], s62 offen sc1
    buffer_store_dwordx4 v[20:23], v24, s[40:43], s62 offen offset:1024 sc1
    s_nop 1
    s_branch Lwus_2
Lwuk_3:
    v_perm_b32 v16, v20, v16, v29
    v_perm_b32 v17, v21, v17, v29
    v_perm_b32 v18, v22, v18, v29
    v_perm_b32 v19, v23, v19, v29
    v_and_b32 v24, 15, v103
    v_cmp_gt_u32 vcc, 4, v24
    v_lshlrev_b32 v24, 4, v24
    v_lshrrev_b32 v25, 4, v103
    v_lshl_add_u32 v24, v25, 6, v24
    s_mov_b64 exec, vcc
    buffer_store_dwordx4 v[16:19], v24, s[40:43], s62 offen offset:2048 sc1
    s_mov_b64 exec, -1
    s_nop 0
Lwus_2:
    v_mov_b32 v10, 0
    s_nop 2
Lnon_4:
    buffer_load_dwordx2 v[8:9], v10, s[44:47], 0 offen sc1
    s_waitcnt vmcnt(0)
    v_readfirstlane_b32 s58, v8
    v_readfirstlane_b32 s59, v9
    s_nop 1
    s_min_u32 s68, s58, s59
    s_cmp_lg_u32 s68, 0
    s_nop 0
    s_cbranch_scc1 Lnond_5
    s_sub_u32 s56, s56, 1
    s_cmp_eq_u32 s56, 0
    s_mov_b32 s69, 7
    s_cbranch_scc1 L_ABORT
    s_sleep 2
    s_branch Lnon_4
Lnond_5:
    s_lshl_b32 s62, s50, 4
    s_add_u32 s62, s62, s52
    s_lshl_b32 s62, s62, 2
    s_add_u32 s62, s62, s49
    s_lshl_b32 s62, s62, 4
    s_add_u32 s62, s62, s51
    s_lshl_b32 s62, s62, 3
    s_add_u32 s62, s62, 21364736
    v_mov_b32 v12, s58
    v_mov_b32 v13, s59
    v_mov_b32 v14, 0
    s_mov_b64 exec, 1
    buffer_store_dwordx2 v[12:13], v14, s[40:43], s62 offen sc1
    s_mov_b64 exec, -1
    s_lshr_b32 s60, s49, 1
    s_lshr_b32 s61, s51, 1
    s_min_u32 s60, s60, s61
    s_cmp_lg_u32 s60, 0
    s_cbranch_scc1 Lwuf_6
    s_lshl_b32 s62, s50, 4
    s_add_u32 s62, s62, s52
    s_and_b32 s63, s51, 1
    s_add_u32 s63, s63, 16
    s_cmp_ge_u32 s49, 2
    s_cselect_b32 s63, s63, s51
    s_lshl_b32 s62, s62, 9
    s_and_b32 s60, s49, 1
    s_mul_i32 s60, s60, 18
    s_add_u32 s63, s63, s60
    s_lshl_b32 s63, s63, 3
    s_add_u32 s62, s62, s63
    s_add_u32 s62, s62, 21495808
    v_mov_b32 v8, s58
    v_mov_b32 v9, s59
    v_mov_b32 v10, 0
    s_mov_b64 exec, 1
    buffer_store_dwordx2 v[8:9], v10, s[40:43], s62 offen sc1
    s_mov_b64 exec, -1
Lwuf_6:
    s_mov_b32 s67, 1
    s_lshl_b32 s68, s49, 2
    v_add_u32 v12, s68, v102
    v_mov_b32 v13, s67
    ds_write_b32 v12, v13 offset:112
    s_mov_b32 s54, 0
    s_mov_b32 s55, s54
    s_lshl_b32 s57, s55, 2
    v_lshrrev_b32 v89, 2, v103
    v_and_b32 v88, 3, v103
    v_and_b32 v90, 1, v88
    v_lshlrev_b32 v90, 1, v90
    v_lshrrev_b32 v85, 1, v88
    v_mul_u32_u24 v85, 12, v85
    v_add_u32 v90, v90, v85
    v_xor_b32 v90, v90, v89
    v_lshlrev_b32 v90, 4, v90
    v_lshl_add_u32 v85, v88, 8, v90
    v_add_u32 v85, s4, v85
    s_lshl_b32 s60, s51, 7
    s_add_u32 s60, s60, s54
    s_lshl_b32 s61, s49, 5
    s_add_u32 s61, s61, s60
    s_mul_i32 s61, s61, 1152
    v_mul_u32_u24 v90, 2304, v89
    v_add_u32 v90, s61, v90
    v_lshl_add_u32 v84, v88, 4, v90
    v_mul_u32_u24 v86, 72, v88
    v_add_u32 v86, v86, v90
    v_lshlrev_b32 v87, 7, v88
    v_lshl_add_u32 v87, v89, 3, v87
    v_add_u32 v87, s4, v87
    buffer_load_dwordx4 v[0:3], v84, s[24:27], 0 offen offset:0
    buffer_load_dwordx4 v[4:7], v84, s[24:27], 0 offen offset:72
    buffer_load_dwordx4 v[8:11], v84, s[24:27], 0 offen offset:144
    buffer_load_dwordx4 v[12:15], v84, s[24:27], 0 offen offset:216
    buffer_load_dwordx4 v[16:19], v84, s[24:27], 0 offen offset:288
    buffer_load_dwordx4 v[20:23], v84, s[24:27], 0 offen offset:360
    buffer_load_dwordx4 v[24:27], v84, s[24:27], 0 offen offset:432
    buffer_load_dwordx4 v[28:31], v84, s[24:27], 0 offen offset:504
    buffer_load_dwordx4 v[32:35], v84, s[24:27], 0 offen offset:576
    buffer_load_dwordx4 v[36:39], v84, s[24:27], 0 offen offset:648
    buffer_load_dwordx4 v[40:43], v84, s[24:27], 0 offen offset:720
    buffer_load_dwordx4 v[44:47], v84, s[24:27], 0 offen offset:792
    buffer_load_dwordx4 v[48:51], v84, s[24:27], 0 offen offset:864
    buffer_load_dwordx4 v[52:55], v84, s[24:27], 0 offen offset:936
    buffer_load_dwordx4 v[56:59], v84, s[24:27], 0 offen offset:1008
    buffer_load_dwordx4 v[60:63], v84, s[24:27], 0 offen offset:1080
    buffer_load_dwordx2 v[64:65], v86, s[24:27], 0 offen offset:64
    buffer_load_dwordx2 v[66:67], v86, s[24:27], 0 offen offset:352
    buffer_load_dwordx2 v[68:69], v86, s[24:27], 0 offen offset:640
    buffer_load_dwordx2 v[70:71], v86, s[24:27], 0 offen offset:928
Lwf_7:
    ds_read_b128 v[88:91], v102 offset:16
    s_waitcnt lgkmcnt(0)
    v_min3_u32 v88, v88, v89, v90
    v_min_u32 v88, v88, v91
    s_nop 0
    v_readfirstlane_b32 s68, v88
    s_nop 1
    s_cmp_ge_u32 s68, s55
    s_nop 1
    s_cbranch_scc1 Lwfd_8
    s_sub_u32 s56, s56, 1
    s_cmp_eq_u32 s56, 0
    s_mov_b32 s69, 6
    s_cbranch_scc1 L_ABORT
    s_branch Lwf_7
Lwfd_8:
    s_waitcnt vmcnt(14)
    ds_write_b128 v85, v[0:3] offset:0
    ds_write_b128 v85, v[4:7] offset:1024
    ds_write_b128 v85, v[8:11] offset:2048
    ds_write_b128 v85, v[12:15] offset:3072
    ds_write_b128 v85, v[16:19] offset:4096
    ds_write_b128 v85, v[20:23] offset:5120
    s_waitcnt vmcnt(8)
    ds_write_b128 v85, v[24:27] offset:6144
    ds_write_b128 v85, v[28:31] offset:7168
    ds_write_b128 v85, v[32:35] offset:8192
    ds_write_b128 v85, v[36:39] offset:9216
    ds_write_b128 v85, v[40:43] offset:10240
    ds_write_b128 v85, v[44:47] offset:11264
    s_waitcnt vmcnt(0)
    ds_write_b128 v85, v[48:51] offset:12288
    ds_write_b128 v85, v[52:55] offset:13312
    ds_write_b128 v85, v[56:59] offset:14336
    ds_write_b128 v85, v[60:63] offset:15360
    ds_write_b64 v87, v[64:65] offset:16384
    ds_write_b64 v87, v[66:67] offset:16896
    ds_write_b64 v87, v[68:69] offset:17408
    ds_write_b64 v87, v[70:71] offset:17920
    v_dot2_f32_bf16 v88, v0, v0, 0
    v_dot2_f32_bf16 v89, v1, v1, 0
    v_dot2_f32_bf16 v88, v2, v2, v88
    v_dot2_f32_bf16 v89, v3, v3, v89
    v_dot2_f32_bf16 v88, v4, v4, v88
    v_dot2_f32_bf16 v89, v5, v5, v89
    v_dot2_f32_bf16 v88, v6, v6, v88
    v_dot2_f32_bf16 v89, v7, v7, v89
    v_dot2_f32_bf16 v88, v8, v8, v88
    v_dot2_f32_bf16 v89, v9, v9, v89
    v_dot2_f32_bf16 v88, v10, v10, v88
    v_dot2_f32_bf16 v89, v11, v11, v89
    v_dot2_f32_bf16 v88, v12, v12, v88
    v_dot2_f32_bf16 v89, v13, v13, v89
    v_dot2_f32_bf16 v88, v14, v14, v88
    v_dot2_f32_bf16 v89, v15, v15, v89
    v_dot2_f32_bf16 v88, v16, v16, v88
    v_dot2_f32_bf16 v89, v17, v17, v89
    v_dot2_f32_bf16 v88, v18, v18, v88
    v_dot2_f32_bf16 v89, v19, v19, v89
    v_dot2_f32_bf16 v88, v20, v20, v88
    v_dot2_f32_bf16 v89, v21, v21, v89
    v_dot2_f32_bf16 v88, v22, v22, v88
    v_dot2_f32_bf16 v89, v23, v23, v89
    v_dot2_f32_bf16 v88, v24, v24, v88
    v_dot2_f32_bf16 v89, v25, v25, v89
    v_dot2_f32_bf16 v88, v26, v26, v88
    v_dot2_f32_bf16 v89, v27, v27, v89
    v_dot2_f32_bf16 v88, v28, v28, v88
    v_dot2_f32_bf16 v89, v29, v29, v89
    v_dot2_f32_bf16 v88, v30, v30, v88
    v_dot2_f32_bf16 v89, v31, v31, v89
    v_dot2_f32_bf16 v88, v32, v32, v88
    v_dot2_f32_bf16 v89, v33, v33, v89
    v_dot2_f32_bf16 v88, v34, v34, v88
    v_dot2_f32_bf16 v89, v35, v35, v89
    v_dot2_f32_bf16 v88, v36, v36, v88
    v_dot2_f32_bf16 v89, v37, v37, v89
    v_dot2_f32_bf16 v88, v38, v38, v88
    v_dot2_f32_bf16 v89, v39, v39, v89
    v_dot2_f32_bf16 v88, v40, v40, v88
    v_dot2_f32_bf16 v89, v41, v41, v89
    v_dot2_f32_bf16 v88, v42, v42, v88
    v_dot2_f32_bf16 v89, v43, v43, v89
    v_dot2_f32_bf16 v88, v44, v44, v88
    v_dot2_f32_bf16 v89, v45, v45, v89
    v_dot2_f32_bf16 v88, v46, v46, v88
    v_dot2_f32_bf16 v89, v47, v47, v89
    v_dot2_f32_bf16 v88, v48, v48, v88
    v_dot2_f32_bf16 v89, v49, v49, v89
    v_dot2_f32_bf16 v88, v50, v50, v88
    v_dot2_f32_bf16 v89, v51, v51, v89
    v_dot2_f32_bf16 v88, v52, v52, v88
    v_dot2_f32_bf16 v89, v53, v53, v89
    v_dot2_f32_bf16 v88, v54, v54, v88
    v_dot2_f32_bf16 v89, v55, v55, v89
    v_dot2_f32_bf16 v88, v56, v56, v88
    v_dot2_f32_bf16 v89, v57, v57, v89
    v_dot2_f32_bf16 v88, v58, v58, v88
    v_dot2_f32_bf16 v89, v59, v59, v89
    v_dot2_f32_bf16 v88, v60, v60, v88
    v_dot2_f32_bf16 v89, v61, v61, v89
    v_dot2_f32_bf16 v88, v62, v62, v88
    v_dot2_f32_bf16 v89, v63, v63, v89
    v_dot2_f32_bf16 v88, v64, v64, v88
    v_dot2_f32_bf16 v89, v65, v65, v89
    v_dot2_f32_bf16 v88, v66, v66, v88
    v_dot2_f32_bf16 v89, v67, v67, v89
    v_dot2_f32_bf16 v88, v68, v68, v88
    v_dot2_f32_bf16 v89, v69, v69, v89
    v_dot2_f32_bf16 v88, v70, v70, v88
    v_dot2_f32_bf16 v89, v71, v71, v89
    s_nop 2
    v_add_f32 v88, v88, v89
    v_mov_b32 v89, 0
    v_subrev_u32 v90, s4, v87
    v_lshrrev_b32 v90, 1, v90
    v_add_u32 v90, s4, v90
    ds_write_b32 v90, v88 offset:18432
    ds_write_b32 v90, v89 offset:18688
    ds_write_b32 v90, v89 offset:18944
    ds_write_b32 v90, v89 offset:19200
    s_waitcnt lgkmcnt(0)
    s_lshl_b32 s68, s49, 2
    v_add_u32 v88, s68, v102
    s_add_u32 s68, s57, 4
    v_mov_b32 v89, s68
    ds_write_b32 v88, v89 offset:0
    s_lshl_b32 s62, s50, 4
    s_add_u32 s62, s62, s52
    s_lshl_b32 s62, s62, 2
    s_add_u32 s62, s62, s49
    s_lshl_b32 s63, s62, 7
    s_add_u32 s63, s63, 21364736
    v_and_b32 v2, 15, v103
    v_lshlrev_b32 v2, 3, v2
    s_nop 2
Lpn_9:
    buffer_load_dwordx2 v[0:1], v2, s[40:43], s63 offen sc1
    s_waitcnt vmcnt(0)
    v_xor_b32 v0, s58, v0
    v_xor_b32 v1, s59, v1
    v_or_b32 v0, v0, v1
    v_cmp_ne_u32 vcc, 0, v0
    s_nop 1
    s_cmp_eq_u64 vcc, 0
    s_nop 1
    s_cbranch_scc1 Lpnd_10
    s_sub_u32 s56, s56, 1
    s_cmp_eq_u32 s56, 0
    s_mov_b32 s69, 15
    s_cbranch_scc1 L_ABORT
    s_sleep 2
    s_branch Lpn_9
Lpnd_10:
    s_mul_i32 s62, s62, 36864
    s_add_u32 s62, s62, 25952256
    v_lshlrev_b32 v2, 4, v103
    buffer_load_dwordx4 v[112:115], v2, s[40:43], s62 offen offset:0 sc1
    buffer_load_dwordx4 v[116:119], v2, s[40:43], s62 offen offset:1024 sc1
    buffer_load_dwordx4 v[120:123], v2, s[40:43], s62 offen offset:2048 sc1
    buffer_load_dwordx4 v[124:127], v2, s[40:43], s62 offen offset:3072 sc1
    s_add_u32 s62, s62, 4096
    buffer_load_dwordx4 v[128:131], v2, s[40:43], s62 offen offset:0 sc1
    buffer_load_dwordx4 v[132:135], v2, s[40:43], s62 offen offset:1024 sc1
    buffer_load_dwordx4 v[136:139], v2, s[40:43], s62 offen offset:2048 sc1
    buffer_load_dwordx4 v[140:143], v2, s[40:43], s62 offen offset:3072 sc1
    s_add_u32 s62, s62, 4096
    buffer_load_dwordx4 v[144:147], v2, s[40:43], s62 offen offset:0 sc1
    buffer_load_dwordx4 v[148:151], v2, s[40:43], s62 offen offset:1024 sc1
    buffer_load_dwordx4 v[152:155], v2, s[40:43], s62 offen offset:2048 sc1
    buffer_load_dwordx4 v[156:159], v2, s[40:43], s62 offen offset:3072 sc1
    s_add_u32 s62, s62, 4096
    buffer_load_dwordx4 v[160:163], v2, s[40:43], s62 offen offset:0 sc1
    buffer_load_dwordx4 v[164:167], v2, s[40:43], s62 offen offset:1024 sc1
    buffer_load_dwordx4 v[168:171], v2, s[40:43], s62 offen offset:2048 sc1
    buffer_load_dwordx4 v[172:175], v2, s[40:43], s62 offen offset:3072 sc1
    s_add_u32 s62, s62, 4096
    buffer_load_dwordx4 v[176:179], v2, s[40:43], s62 offen offset:0 sc1
    buffer_load_dwordx4 v[180:183], v2, s[40:43], s62 offen offset:1024 sc1
    buffer_load_dwordx4 v[184:187], v2, s[40:43], s62 offen offset:2048 sc1
    buffer_load_dwordx4 v[188:191], v2, s[40:43], s62 offen offset:3072 sc1
    s_add_u32 s62, s62, 4096
    buffer_load_dwordx4 v[192:195], v2, s[40:43], s62 offen offset:0 sc1
    buffer_load_dwordx4 v[196:199], v2, s[40:43], s62 offen offset:1024 sc1
    buffer_load_dwordx4 v[200:203], v2, s[40:43], s62 offen offset:2048 sc1
    buffer_load_dwordx4 v[204:207], v2, s[40:43], s62 offen offset:3072 sc1
    s_add_u32 s62, s62, 4096
    buffer_load_dwordx4 v[208:211], v2, s[40:43], s62 offen offset:0 sc1
    buffer_load_dwordx4 v[212:215], v2, s[40:43], s62 offen offset:1024 sc1
    buffer_load_dwordx4 v[216:219], v2, s[40:43], s62 offen offset:2048 sc1
    buffer_load_dwordx4 v[220:223], v2, s[40:43], s62 offen offset:3072 sc1
    s_add_u32 s62, s62, 4096
    buffer_load_dwordx4 v[224:227], v2, s[40:43], s62 offen offset:0 sc1
    buffer_load_dwordx4 v[228:231], v2, s[40:43], s62 offen offset:1024 sc1
    buffer_load_dwordx4 v[232:235], v2, s[40:43], s62 offen offset:2048 sc1
    buffer_load_dwordx4 v[236:239], v2, s[40:43], s62 offen offset:3072 sc1
    s_add_u32 s62, s62, 4096
    buffer_load_dwordx4 v[240:243], v2, s[40:43], s62 offen offset:0 sc1
    buffer_load_dwordx4 v[244:247], v2, s[40:43], s62 offen offset:1024 sc1
    buffer_load_dwordx4 v[248:251], v2, s[40:43], s62 offen offset:2048 sc1
    buffer_load_dwordx4 v[252:255], v2, s[40:43], s62 offen offset:3072 sc1
    v_mov_b32 v8, 0x3f803f80
    v_mov_b32 v9, 0x3f803f80
    v_mov_b32 v10, 0x3f803f80
    v_mov_b32 v11, 0x3f803f80
    s_waitcnt vmcnt(34)
    s_nop 0
    v_mfma_f32_16x16x32_bf16 v[104:107], v[112:115], v[8:11], 0
    v_mfma_f32_16x16x32_bf16 v[108:111], v[116:119], v[8:11], 0
    s_waitcnt vmcnt(32)
    v_mfma_f32_16x16x32_bf16 v[104:107], v[120:123], v[8:11], v[104:107]
    v_mfma_f32_16x16x32_bf16 v[108:111], v[124:127], v[8:11], v[108:111]
    s_waitcnt vmcnt(30)
    v_mfma_f32_16x16x32_bf16 v[104:107], v[128:131], v[8:11], v[104:107]
    v_mfma_f32_16x16x32_bf16 v[108:111], v[132:135], v[8:11], v[108:111]
    s_waitcnt vmcnt(28)
    v_mfma_f32_16x16x32_bf16 v[104:107], v[136:139], v[8:11], v[104:107]
    v_mfma_f32_16x16x32_bf16 v[108:111], v[140:143], v[8:11], v[108:111]
    s_waitcnt vmcnt(26)
    v_mfma_f32_16x16x32_bf16 v[104:107], v[144:147], v[8:11], v[104:107]
    v_mfma_f32_16x16x32_bf16 v[108:111], v[148:151], v[8:11], v[108:111]
    s_waitcnt vmcnt(24)
    v_mfma_f32_16x16x32_bf16 v[104:107], v[152:155], v[8:11], v[104:107]
    v_mfma_f32_16x16x32_bf16 v[108:111], v[156:159], v[8:11], v[108:111]
    s_waitcnt vmcnt(22)
    v_mfma_f32_16x16x32_bf16 v[104:107], v[160:163], v[8:11], v[104:107]
    v_mfma_f32_16x16x32_bf16 v[108:111], v[164:167], v[8:11], v[108:111]
    s_waitcnt vmcnt(20)
    v_mfma_f32_16x16x32_bf16 v[104:107], v[168:171], v[8:11], v[104:107]
    v_mfma_f32_16x16x32_bf16 v[108:111], v[172:175], v[8:11], v[108:111]
    s_waitcnt vmcnt(18)
    v_mfma_f32_16x16x32_bf16 v[104:107], v[176:179], v[8:11], v[104:107]
    v_mfma_f32_16x16x32_bf16 v[108:111], v[180:183], v[8:11], v[108:111]
    s_waitcnt vmcnt(16)
    v_mfma_f32_16x16x32_bf16 v[104:107], v[184:187], v[8:11], v[104:107]
    v_mfma_f32_16x16x32_bf16 v[108:111], v[188:191], v[8:11], v[108:111]
    s_waitcnt vmcnt(14)
    v_mfma_f32_16x16x32_bf16 v[104:107], v[192:195], v[8:11], v[104:107]
    v_mfma_f32_16x16x32_bf16 v[108:111], v[196:199], v[8:11], v[108:111]
    s_waitcnt vmcnt(12)
    v_mfma_f32_16x16x32_bf16 v[104:107], v[200:203], v[8:11], v[104:107]
    v_mfma_f32_16x16x32_bf16 v[108:111], v[204:207], v[8:11], v[108:111]
    s_waitcnt vmcnt(10)
    v_mfma_f32_16x16x32_bf16 v[104:107], v[208:211], v[8:11], v[104:107]
    v_mfma_f32_16x16x32_bf16 v[108:111], v[212:215], v[8:11], v[108:111]
    s_waitcnt vmcnt(8)
    v_mfma_f32_16x16x32_bf16 v[104:107], v[216:219], v[8:11], v[104:107]
    v_mfma_f32_16x16x32_bf16 v[108:111], v[220:223], v[8:11], v[108:111]
    s_waitcnt vmcnt(6)
    v_mfma_f32_16x16x32_bf16 v[104:107], v[224:227], v[8:11], v[104:107]
    v_mfma_f32_16x16x32_bf16 v[108:111], v[228:231], v[8:11], v[108:111]
    s_waitcnt vmcnt(4)
    v_mfma_f32_16x16x32_bf16 v[104:107], v[232:235], v[8:11], v[104:107]
    v_mfma_f32_16x16x32_bf16 v[108:111], v[236:239], v[8:11], v[108:111]
    s_waitcnt vmcnt(2)
    v_mfma_f32_16x16x32_bf16 v[104:107], v[240:243], v[8:11], v[104:107]
    v_mfma_f32_16x16x32_bf16 v[108:111], v[244:247], v[8:11], v[108:111]
    s_waitcnt vmcnt(0)
    v_mfma_f32_16x16x32_bf16 v[104:107], v[248:251], v[8:11], v[104:107]
    v_mfma_f32_16x16x32_bf16 v[108:111], v[252:255], v[8:11], v[108:111]
    s_mov_b32 s67, 2
    s_lshl_b32 s68, s49, 2
    v_add_u32 v12, s68, v102
    v_mov_b32 v13, s67
    ds_write_b32 v12, v13 offset:112
    s_nop 2
    s_branch L_M_ROLE
L_H0:
    s_cmp_lg_u32 s2, 0
    s_cbranch_scc1 Lnn_11
    s_cmp_lg_u32 s49, 0
    s_cbranch_scc1 Lnn_11
    s_memrealtime s[58:59]
    s_waitcnt lgkmcnt(0)
    s_or_b32 s58, s58, 1
    s_or_b32 s59, s59, 1
    v_mov_b32 v72, s58
    v_mov_b32 v73, s59
    v_mov_b32 v74, 0
    buffer_store_dwordx2 v[72:73], v74, s[44:47], 0 offen sc1
    s_nop 1
Lnn_11:
    v_and_b32 v92, 15, v103
    v_lshrrev_b32 v93, 4, v103
    v_lshrrev_b32 v94, 2, v92
    v_and_b32 v95, 3, v92
    s_mul_i32 s60, s49, 3
    v_add_u32 v96, s60, v94
    v_lshrrev_b32 v99, 2, v96
    v_mul_u32_u24 v99, 576, v99
    v_bfe_u32 v97, v96, 1, 1
    v_mul_u32_u24 v97, 18, v97
    v_add_u32 v99, v99, v97
    v_and_b32 v97, 1, v96
    v_lshl_add_u32 v99, v97, 3, v99
    v_lshl_add_u32 v99, v95, 1, v99
    s_mul_i32 s60, s49, 576
    s_add_u32 s60, s60, 16
    v_mul_u32_u24 v97, 18, v95
    v_add_u32 v97, s60, v97
    v_cmp_eq_u32 vcc, 3, v94
    s_nop 1
    v_cndmask_b32 v99, v99, v97, vcc
    s_mul_i32 s60, s52, 36
    v_add_u32 v99, s60, v99
    v_lshlrev_b32 v99, 1, v99
    s_cmp_eq_u32 s49, 3
    s_cselect_b32 s60, 12, 14
    v_cmp_le_u32 vcc, s60, v92
    v_mov_b32 v97, 0x7f000000
    s_nop 0
    v_cndmask_b32 v99, v99, v97, vcc
    s_mov_b32 s60, 248832
    v_mul_lo_u32 v97, v93, s60
    v_add_u32 v100, v99, v97
    v_mul_u32_u24 v97, 27648, v93
    v_add_u32 v99, v99, v97
    s_mul_i32 s62, s51, 124416
    s_and_b32 s63, s51, 1
    s_mul_i32 s63, s63, 995328
    s_add_u32 s60, s62, 0
    buffer_load_dword v112, v99, s[28:31], s60 offen
    buffer_load_dword v116, v99, s[28:31], s60 offen offset:3456
    s_add_u32 s61, s62, 6912
    buffer_load_dword v113, v99, s[28:31], s61 offen
    buffer_load_dword v117, v99, s[28:31], s61 offen offset:3456
    s_add_u32 s60, s62, 13824
    buffer_load_dword v114, v99, s[28:31], s60 offen
    buffer_load_dword v118, v99, s[28:31], s60 offen offset:3456
    s_add_u32 s61, s62, 20736
    buffer_load_dword v115, v99, s[28:31], s61 offen
    buffer_load_dword v119, v99, s[28:31], s61 offen offset:3456
    s_add_u32 s60, s63, 110592
    buffer_load_dword v120, v100, s[28:31], s60 offen
    buffer_load_dword v124, v100, s[28:31], s60 offen offset:3456
    s_add_u32 s61, s63, 117504
    buffer_load_dword v121, v100, s[28:31], s61 offen
    buffer_load_dword v125, v100, s[28:31], s61 offen offset:3456
    s_add_u32 s60, s63, 235008
    buffer_load_dword v122, v100, s[28:31], s60 offen
    buffer_load_dword v126, v100, s[28:31], s60 offen offset:3456
    s_add_u32 s61, s63, 241920
    buffer_load_dword v123, v100, s[28:31], s61 offen
    buffer_load_dword v127, v100, s[28:31], s61 offen offset:3456
    v_and_b32 v92, 15, v103
    v_lshrrev_b32 v93, 4, v103
    v_lshrrev_b32 v94, 1, v93
    v_mul_u32_u24 v94, 18, v94
    v_and_b32 v95, 1, v93
    v_lshl_add_u32 v94, v95, 3, v94
    v_mul_u32_u24 v95, 72, v93
    s_cmp_ge_u32 s49, 2
    s_cselect_b64 vcc, -1, 0
    v_cndmask_b32 v94, v94, v95, vcc
    v_mul_u32_u24 v96, 1152, v94
    v_lshlrev_b32 v94, 2, v92
    v_and_b32 v95, 2, v92
    v_lshlrev_b32 v95, 1, v95
    v_add_u32 v95, 64, v95
    s_and_b32 s60, s49, 1
    s_cmp_eq_u32 s60, 1
    s_cselect_b64 vcc, -1, 0
    v_cndmask_b32 v94, v94, v95, vcc
    s_mul_i32 s60, s52, 72
    v_add3_u32 v96, v96, v94, s60
    v_and_b32 v94, 1, v92
    v_cmp_eq_u32 vcc, 1, v94
    v_mov_b32 v94, s72
    v_mov_b32 v95, s73
    v_cndmask_b32 v97, v94, v95, vcc
    s_mul_i32 s62, s51, 41472
    s_and_b32 s63, s51, 1
    s_mul_i32 s63, s63, 331776
    s_cmp_ge_u32 s49, 2
    s_cselect_b32 s60, s63, s62
    s_mov_b32 s64, 0
    s_mov_b32 s65, 18432
    s_cselect_b32 s61, s65, s64
    s_add_u32 s66, s60, s61
    buffer_load_dword v72, v96, s[32:35], s66 offen
    buffer_load_dword v76, v96, s[32:35], s66 offen offset:1152
    s_cmp_ge_u32 s49, 2
    s_cselect_b32 s60, s63, s62
    s_mov_b32 s64, 2304
    s_mov_b32 s65, 39168
    s_cselect_b32 s61, s65, s64
    s_add_u32 s67, s60, s61
    buffer_load_dword v73, v96, s[32:35], s67 offen
    buffer_load_dword v77, v96, s[32:35], s67 offen offset:1152
    s_cmp_ge_u32 s49, 2
    s_cselect_b32 s60, s63, s62
    s_mov_b32 s64, 4608
    s_mov_b32 s65, 59904
    s_cselect_b32 s61, s65, s64
    s_add_u32 s66, s60, s61
    buffer_load_dword v74, v96, s[32:35], s66 offen
    buffer_load_dword v78, v96, s[32:35], s66 offen offset:1152
    s_cmp_ge_u32 s49, 2
    s_cselect_b32 s60, s63, s62
    s_mov_b32 s64, 6912
    s_mov_b32 s65, 80640
    s_cselect_b32 s61, s65, s64
    s_add_u32 s67, s60, s61
    buffer_load_dword v75, v96, s[32:35], s67 offen
    buffer_load_dword v79, v96, s[32:35], s67 offen offset:1152
    s_cmp_ge_u32 s49, 2
    v_lshlrev_b32 v80, 4, v103
    s_mul_i32 s60, s49, 576
    v_add_u32 v80, s60, v80
    v_mov_b32 v82, -1
    v_mov_b32 v83, -1
    v_mov_b32 v84, -1
    v_mov_b32 v85, -1
    s_mov_b32 s54, 0
    s_lshl_b32 s62, s50, 5
    s_lshl_b32 s61, s51, 1
    s_add_u32 s62, s62, s61
    s_add_u32 s62, s62, s54
    s_lshl_b32 s62, s62, 4
    s_add_u32 s62, s62, s52
    s_mul_i32 s62, s62, 2304
    s_add_u32 s62, s62, 14155776
    s_mov_b32 exec_lo, -1
    s_mov_b32 exec_hi, 15
    s_add_u32 s63, s62, 0
    buffer_store_dwordx4 v[82:85], v80, s[40:43], s63 offen sc1
    s_add_u32 s63, s62, 36864
    buffer_store_dwordx4 v[82:85], v80, s[40:43], s63 offen sc1
    s_add_u32 s63, s62, 2359296
    buffer_store_dwordx4 v[82:85], v80, s[40:43], s63 offen sc1
    s_add_u32 s63, s62, 2396160
    buffer_store_dwordx4 v[82:85], v80, s[40:43], s63 offen sc1
    s_mov_b64 exec, -1
    s_waitcnt vmcnt(4)
    v_and_b32 v105, 15, v103
    v_cmp_eq_u32 vcc, 14, v105
    v_mov_b32 v105, 0x3f803f80
    s_nop 0
    v_cndmask_b32 v104, 0, v105, vcc
    v_perm_b32 v106, v116, v112, s72
    v_perm_b32 v116, v116, v112, s73
    v_or_b32 v112, v104, v106
    v_perm_b32 v107, v117, v113, s72
    v_perm_b32 v117, v117, v113, s73
    v_or_b32 v113, v104, v107
    v_perm_b32 v106, v118, v114, s72
    v_perm_b32 v118, v118, v114, s73
    v_or_b32 v114, v104, v106
    v_perm_b32 v107, v119, v115, s72
    v_perm_b32 v119, v119, v115, s73
    v_or_b32 v115, v104, v107
    v_perm_b32 v106, v124, v120, s72
    v_perm_b32 v124, v124, v120, s73
    v_or_b32 v120, v104, v106
    v_perm_b32 v107, v125, v121, s72
    v_perm_b32 v125, v125, v121, s73
    v_or_b32 v121, v104, v107
    v_perm_b32 v106, v126, v122, s72
    v_perm_b32 v126, v126, v122, s73
    v_or_b32 v122, v104, v106
    v_perm_b32 v107, v127, v123, s72
    v_perm_b32 v127, v127, v123, s73
    v_or_b32 v123, v104, v107
    s_lshl_b32 s62, s50, 4
    s_add_u32 s62, s62, s52
    s_lshl_b32 s62, s62, 2
    s_add_u32 s62, s62, s49
    s_mul_i32 s62, s62, 36864
    s_add_u32 s62, s62, 25952256
    s_lshl_b32 s63, s51, 11
    s_add_u32 s63, s63, s62
    v_lshlrev_b32 v108, 4, v103
    buffer_store_dwordx4 v[112:115], v108, s[40:43], s63 offen sc1
    buffer_store_dwordx4 v[116:119], v108, s[40:43], s63 offen offset:1024 sc1
    s_cmp_ge_u32 s51, 2
    s_nop 0
    s_cbranch_scc1 Lcs_13
    s_add_u32 s63, s63, 32768
    buffer_store_dwordx4 v[120:123], v108, s[40:43], s63 offen sc1
    buffer_store_dwordx4 v[124:127], v108, s[40:43], s63 offen offset:1024 sc1
    s_nop 1
Lcs_13:
    s_lshr_b32 s60, s49, 1
    s_lshr_b32 s61, s51, 1
    s_min_u32 s60, s60, s61
    s_cmp_lg_u32 s60, 0
    s_cbranch_scc1 Lwus_14
    s_lshl_b32 s62, s50, 4
    s_add_u32 s62, s62, s52
    s_and_b32 s63, s51, 1
    s_add_u32 s63, s63, 16
    s_cmp_ge_u32 s49, 2
    s_cselect_b32 s63, s63, s51
    s_mul_i32 s62, s62, 41984
    s_mul_i32 s63, s63, 2304
    s_add_u32 s62, s62, s63
    s_add_u32 s62, s62, 30670848
    s_and_b32 s60, s49, 1
    s_cmp_eq_u32 s60, 1
    s_cbranch_scc1 Lwuk_15
    v_perm_b32 v92, v76, v72, s72
    v_perm_b32 v76, v76, v72, s73
    v_mov_b32 v72, v92
    v_perm_b32 v93, v77, v73, s72
    v_perm_b32 v77, v77, v73, s73
    v_mov_b32 v73, v93
    v_perm_b32 v92, v78, v74, s72
    v_perm_b32 v78, v78, v74, s73
    v_mov_b32 v74, v92
    v_perm_b32 v93, v79, v75, s72
    v_perm_b32 v79, v79, v75, s73
    v_mov_b32 v75, v93
    v_lshlrev_b32 v92, 4, v103
    buffer_store_dwordx4 v[72:75], v92, s[40:43], s62 offen sc1
    buffer_store_dwordx4 v[76:79], v92, s[40:43], s62 offen offset:1024 sc1
    s_nop 1
    s_branch Lwus_14
Lwuk_15:
    v_perm_b32 v72, v76, v72, v97
    v_perm_b32 v73, v77, v73, v97
    v_perm_b32 v74, v78, v74, v97
    v_perm_b32 v75, v79, v75, v97
    v_and_b32 v92, 15, v103
    v_cmp_gt_u32 vcc, 4, v92
    v_lshlrev_b32 v92, 4, v92
    v_lshrrev_b32 v93, 4, v103
    v_lshl_add_u32 v92, v93, 6, v92
    s_mov_b64 exec, vcc
    buffer_store_dwordx4 v[72:75], v92, s[40:43], s62 offen offset:2048 sc1
    s_mov_b64 exec, -1
    s_nop 0
Lwus_14:
    v_mov_b32 v74, 0
    s_nop 2
Lnon_16:
    buffer_load_dwordx2 v[72:73], v74, s[44:47], 0 offen sc1
    s_waitcnt vmcnt(0)
    v_readfirstlane_b32 s58, v72
    v_readfirstlane_b32 s59, v73
    s_nop 1
    s_min_u32 s68, s58, s59
    s_cmp_lg_u32 s68, 0
    s_nop 0
    s_cbranch_scc1 Lnond_17
    s_sub_u32 s56, s56, 1
    s_cmp_eq_u32 s56, 0
    s_mov_b32 s69, 7
    s_cbranch_scc1 L_ABORT
    s_sleep 2
    s_branch Lnon_16
Lnond_17:
    s_mov_b32 s67, 1
    s_lshl_b32 s68, s49, 2
    v_add_u32 v72, s68, v102
    v_mov_b32 v73, s67
    ds_write_b32 v72, v73 offset:128
    s_cmp_lg_u32 s49, 3
    s_nop 0
    s_cbranch_scc1 Lif_18
Lwf_19:
    ds_read_b128 v[72:75], v102 offset:112
    s_waitcnt lgkmcnt(0)
    v_min3_u32 v72, v72, v73, v74
    v_min_u32 v72, v72, v75
    s_nop 0
    v_readfirstlane_b32 s68, v72
    s_nop 1
    s_cmp_ge_u32 s68, s67
    s_nop 1
    s_cbranch_scc1 Lwfd_20
    s_sub_u32 s56, s56, 1
    s_cmp_eq_u32 s56, 0
    s_mov_b32 s69, 18
    s_cbranch_scc1 L_ABORT
    s_branch Lwf_19
Lwfd_20:
Lwf_21:
    ds_read_b128 v[72:75], v102 offset:128
    s_waitcnt lgkmcnt(0)
    v_min3_u32 v72, v72, v73, v74
    v_min_u32 v72, v72, v75
    s_nop 0
    v_readfirstlane_b32 s68, v72
    s_nop 1
    s_cmp_ge_u32 s68, s67
    s_nop 1
    s_cbranch_scc1 Lwfd_22
    s_sub_u32 s56, s56, 1
    s_cmp_eq_u32 s56, 0
    s_mov_b32 s69, 19
    s_cbranch_scc1 L_ABORT
    s_branch Lwf_21
Lwfd_22:
    s_lshl_b32 s60, s51, 4
    s_add_u32 s60, s60, s52
    s_lshl_b32 s60, s60, 4
    s_add_u32 s60, s60, 21299200
    v_mov_b32 v72, s58
    v_mov_b32 v73, s59
    v_mov_b32 v74, s93
    v_mov_b32 v75, s58
    v_mov_b32 v76, 0
    s_mov_b64 exec, 1
    buffer_store_dwordx4 v[72:75], v76, s[40:43], s60 offen sc1
    s_mov_b64 exec, -1
    s_nop 0
Lif_18:
    s_lshl_b32 s62, s50, 4
    s_add_u32 s62, s62, s52
    s_lshl_b32 s62, s62, 2
    s_add_u32 s62, s62, s49
    s_lshl_b32 s62, s62, 4
    s_add_u32 s62, s62, s51
    s_lshl_b32 s62, s62, 3
    s_add_u32 s62, s62, 21364736
    v_mov_b32 v78, s58
    v_mov_b32 v79, s59
    v_mov_b32 v80, 0
    s_mov_b64 exec, 1
    buffer_store_dwordx2 v[78:79], v80, s[40:43], s62 offen sc1
    s_mov_b64 exec, -1
    s_lshr_b32 s60, s49, 1
    s_lshr_b32 s61, s51, 1
    s_min_u32 s60, s60, s61
    s_cmp_lg_u32 s60, 0
    s_cbranch_scc1 Lwuf_23
    s_lshl_b32 s62, s50, 4
    s_add_u32 s62, s62, s52
    s_and_b32 s63, s51, 1
    s_add_u32 s63, s63, 16
    s_cmp_ge_u32 s49, 2
    s_cselect_b32 s63, s63, s51
    s_lshl_b32 s62, s62, 9
    s_and_b32 s60, s49, 1
    s_mul_i32 s60, s60, 18
    s_add_u32 s63, s63, s60
    s_lshl_b32 s63, s63, 3
    s_add_u32 s62, s62, s63
    s_add_u32 s62, s62, 21495808
    v_mov_b32 v92, s58
    v_mov_b32 v93, s59
    v_mov_b32 v94, 0
    s_mov_b64 exec, 1
    buffer_store_dwordx2 v[92:93], v94, s[40:43], s62 offen sc1
    s_mov_b64 exec, -1
Lwuf_23:
    v_lshrrev_b32 v84, 2, v103
    v_bfe_u32 v85, v103, 1, 1
    v_and_b32 v86, 1, v103
    s_lshl_b32 s60, s49, 4
    s_add_u32 s60, s60, 16
    v_add_u32 v87, s60, v84
    v_mul_u32_u24 v76, 272, v87
    v_add_u32 v76, 0x13000, v76
    v_lshl_add_u32 v70, v85, 7, v76
    v_lshl_add_u32 v71, v85, 2, v76
    v_mul_u32_u24 v77, 1088, v86
    v_add_u32 v77, 816, v77
    v_sub_u32 v72, v70, v77
    v_sub_u32 v73, v71, v77
    v_lshlrev_b32 v78, 2, v87
    v_add_u32 v78, 0x22700, v78
    v_lshlrev_b32 v79, 4, v86
    v_add_u32 v79, 12, v79
    v_sub_u32 v79, v78, v79
    v_lshl_add_u32 v74, v86, 6, v70
    v_subrev_u32 v74, 1904, v74
    v_subrev_u32 v75, 1904, v71
    v_lshl_add_u32 v80, v85, 1, v86
    v_lshlrev_b32 v80, 8, v80
    v_lshl_add_u32 v88, v84, 4, v80
    s_lshl_b32 s60, s52, 10
    v_add_u32 v88, s60, v88
    s_lshl_b32 s60, s52, 7
    s_add_u32 s60, s60, 16384
    v_lshlrev_b32 v80, 3, v84
    v_lshl_add_u32 v80, v85, 2, v80
    v_add_u32 v89, s60, v80
    v_mov_b32 v76, v78
    v_mov_b32 v77, v79
    v_mov_b32 v90, v84
    v_mov_b32 v91, v86
    v_lshlrev_b32 v92, 4, v103
    v_add_u32 v92, s8, v92
    ds_write_b128 v92, v[70:73]
    ds_write_b128 v92, v[74:77] offset:1024
    ds_write_b128 v92, v[88:91] offset:2048
    v_lshlrev_b32 v72, 4, v103
    v_add_u32 v72, 0x18500, v72
    v_and_b32 v73, 3, v103
    v_lshlrev_b32 v73, 4, v73
    v_lshrrev_b32 v75, 4, v103
    v_lshl_add_u32 v73, v75, 6, v73
    v_add_u32 v73, 0x18d00, v73
    v_and_b32 v74, 15, v103
    v_lshlrev_b32 v74, 3, v74
    v_lshl_add_u32 v74, v75, 8, v74
    s_mov_b32 s54, 0
    v_lshrrev_b32 v80, 4, v103
    v_and_b32 v81, 15, v103
    v_and_b32 v82, 1, v80
    v_lshlrev_b32 v82, 1, v82
    v_lshrrev_b32 v76, 1, v80
    v_mul_u32_u24 v76, 12, v76
    v_add_u32 v82, v82, v76
    v_xor_b32 v82, v82, v81
    v_lshlrev_b32 v82, 4, v82
    v_lshl_add_u32 v76, v80, 8, v82
    s_lshl_b32 s60, s52, 10
    v_add_u32 v76, s60, v76
    s_lshl_b32 s60, s52, 7
    s_add_u32 s60, s60, 16384
    v_lshlrev_b32 v81, 3, v81
    v_add_u32 v77, s60, v81
    s_lshl_b32 s60, s51, 7
    s_add_u32 s60, s60, s54
    s_lshl_b32 s61, s49, 5
    s_add_u32 s60, s60, s61
    s_mul_i32 s60, s60, 1152
    s_mul_i32 s61, s52, 72
    s_add_u32 s60, s60, s61
    v_and_b32 v80, 15, v103
    v_mul_u32_u24 v80, 2304, v80
    v_add_u32 v80, s60, v80
    v_add_u32 v79, 64, v80
    v_lshrrev_b32 v81, 4, v103
    v_lshl_add_u32 v78, v81, 4, v80
    ds_write_b128 v92, v[72:75] offset:3072
    ds_write_b128 v92, v[76:79] offset:4096
    s_waitcnt lgkmcnt(0)
    s_mov_b32 s67, 2
    s_lshl_b32 s68, s49, 2
    v_add_u32 v72, s68, v102
    v_mov_b32 v73, s67
    ds_write_b32 v72, v73 offset:128
    s_nop 1
Lwf_24:
    ds_read_b128 v[72:75], v102 offset:112
    s_waitcnt lgkmcnt(0)
    v_min3_u32 v72, v72, v73, v74
    v_min_u32 v72, v72, v75
    s_nop 0
    v_readfirstlane_b32 s68, v72
    s_nop 1
    s_cmp_ge_u32 s68, s67
    s_nop 1
    s_cbranch_scc1 Lwfd_25
    s_sub_u32 s56, s56, 1
    s_cmp_eq_u32 s56, 0
    s_mov_b32 s69, 20
    s_cbranch_scc1 L_ABORT
    s_sleep 4
    s_branch Lwf_24
Lwfd_25:
    s_mov_b32 s54, 1
    s_mov_b32 s55, s54
    s_lshl_b32 s57, s55, 2
    v_lshrrev_b32 v89, 2, v103
    v_and_b32 v88, 3, v103
    v_and_b32 v90, 1, v88
    v_lshlrev_b32 v90, 1, v90
    v_lshrrev_b32 v85, 1, v88
    v_mul_u32_u24 v85, 12, v85
    v_add_u32 v90, v90, v85
    v_xor_b32 v90, v90, v89
    v_lshlrev_b32 v90, 4, v90
    v_lshl_add_u32 v85, v88, 8, v90
    v_add_u32 v85, s4, v85
    s_lshl_b32 s60, s51, 7
    s_add_u32 s60, s60, s54
    s_lshl_b32 s61, s49, 5
    s_add_u32 s61, s61, s60
    s_mul_i32 s61, s61, 1152
    v_mul_u32_u24 v90, 2304, v89
    v_add_u32 v90, s61, v90
    v_lshl_add_u32 v84, v88, 4, v90
    v_mul_u32_u24 v86, 72, v88
    v_add_u32 v86, v86, v90
    v_lshlrev_b32 v87, 7, v88
    v_lshl_add_u32 v87, v89, 3, v87
    v_add_u32 v87, s4, v87
    buffer_load_dwordx4 v[0:3], v84, s[24:27], 0 offen offset:0
    buffer_load_dwordx4 v[4:7], v84, s[24:27], 0 offen offset:72
    buffer_load_dwordx4 v[8:11], v84, s[24:27], 0 offen offset:144
    buffer_load_dwordx4 v[12:15], v84, s[24:27], 0 offen offset:216
    buffer_load_dwordx4 v[16:19], v84, s[24:27], 0 offen offset:288
    buffer_load_dwordx4 v[20:23], v84, s[24:27], 0 offen offset:360
    buffer_load_dwordx4 v[24:27], v84, s[24:27], 0 offen offset:432
    buffer_load_dwordx4 v[28:31], v84, s[24:27], 0 offen offset:504
    buffer_load_dwordx4 v[32:35], v84, s[24:27], 0 offen offset:576
    buffer_load_dwordx4 v[36:39], v84, s[24:27], 0 offen offset:648
    buffer_load_dwordx4 v[40:43], v84, s[24:27], 0 offen offset:720
    buffer_load_dwordx4 v[44:47], v84, s[24:27], 0 offen offset:792
    buffer_load_dwordx4 v[48:51], v84, s[24:27], 0 offen offset:864
    buffer_load_dwordx4 v[52:55], v84, s[24:27], 0 offen offset:936
    buffer_load_dwordx4 v[56:59], v84, s[24:27], 0 offen offset:1008
    buffer_load_dwordx4 v[60:63], v84, s[24:27], 0 offen offset:1080
    buffer_load_dwordx2 v[64:65], v86, s[24:27], 0 offen offset:64
    buffer_load_dwordx2 v[66:67], v86, s[24:27], 0 offen offset:352
    buffer_load_dwordx2 v[68:69], v86, s[24:27], 0 offen offset:640
    buffer_load_dwordx2 v[70:71], v86, s[24:27], 0 offen offset:928
    s_lshl_b32 s62, s50, 4
    s_add_u32 s62, s62, s52
    s_cmp_lg_u32 s94, 0
    s_cbranch_scc1 Lwook_26
    s_lshl_b32 s63, s62, 9
    s_add_u32 s63, s63, 21495808
    v_min_u32 v90, 35, v103
    v_lshlrev_b32 v90, 3, v90
    s_nop 2
Lpn_27:
    buffer_load_dwordx2 v[88:89], v90, s[40:43], s63 offen sc1
    s_waitcnt vmcnt(0)
    v_xor_b32 v88, s58, v88
    v_xor_b32 v89, s59, v89
    v_or_b32 v88, v88, v89
    v_cmp_ne_u32 vcc, 0, v88
    s_nop 1
    s_cmp_eq_u64 vcc, 0
    s_nop 1
    s_cbranch_scc1 Lpnd_28
    s_sub_u32 s56, s56, 1
    s_cmp_eq_u32 s56, 0
    s_mov_b32 s69, 16
    s_cbranch_scc1 L_ABORT
    s_sleep 2
    s_branch Lpn_27
Lpnd_28:
    s_mov_b32 s94, 1
Lwook_26:
    s_mul_i32 s62, s62, 41984
    s_mul_i32 s63, s49, 10240
    s_add_u32 s62, s62, s63
    s_add_u32 s83, s62, 30670848
    s_add_u32 s84, s63, 99584
    v_lshlrev_b32 v92, 4, v103
    s_nop 2
Lwf_29:
    ds_read_b128 v[88:91], v102 offset:80
    s_waitcnt lgkmcnt(0)
    v_min3_u32 v88, v88, v89, v90
    v_min_u32 v88, v88, v91
    s_nop 0
    v_readfirstlane_b32 s68, v88
    s_nop 1
    s_cmp_ge_u32 s68, s53
    s_nop 1
    s_cbranch_scc1 Lwfd_30
    s_sub_u32 s56, s56, 1
    s_cmp_eq_u32 s56, 0
    s_mov_b32 s69, 9
    s_cbranch_scc1 L_ABORT
    s_branch Lwf_29
Lwfd_30:
Lwf_31:
    ds_read_b128 v[88:91], v102 offset:96
    s_waitcnt lgkmcnt(0)
    v_min3_u32 v88, v88, v89, v90
    v_min_u32 v88, v88, v91
    s_nop 0
    v_readfirstlane_b32 s68, v88
    s_nop 1
    s_cmp_ge_u32 s68, s53
    s_nop 1
    s_cbranch_scc1 Lwfd_32
    s_sub_u32 s56, s56, 1
    s_cmp_eq_u32 s56, 0
    s_mov_b32 s69, 14
    s_cbranch_scc1 L_ABORT
    s_branch Lwf_31
Lwfd_32:
    s_add_u32 s60, s83, 0
    s_add_u32 s61, s84, 0
    s_mov_b32 m0, s61
    s_nop 0
    buffer_load_dwordx4 v92, s[40:43], s60 offen offset:0 sc1 lds
    buffer_load_dwordx4 v92, s[40:43], s60 offen offset:1024 sc1 lds
    buffer_load_dwordx4 v92, s[40:43], s60 offen offset:2048 sc1 lds
    buffer_load_dwordx4 v92, s[40:43], s60 offen offset:3072 sc1 lds
    s_add_u32 s60, s83, 4096
    s_add_u32 s61, s84, 4096
    s_mov_b32 m0, s61
    s_nop 0
    buffer_load_dwordx4 v92, s[40:43], s60 offen offset:0 sc1 lds
    buffer_load_dwordx4 v92, s[40:43], s60 offen offset:1024 sc1 lds
    buffer_load_dwordx4 v92, s[40:43], s60 offen offset:2048 sc1 lds
    buffer_load_dwordx4 v92, s[40:43], s60 offen offset:3072 sc1 lds
    s_add_u32 s60, s83, 8192
    s_add_u32 s61, s84, 8192
    s_mov_b32 m0, s61
    s_nop 0
    buffer_load_dwordx4 v92, s[40:43], s60 offen offset:0 sc1 lds
    buffer_load_dwordx4 v92, s[40:43], s60 offen offset:1024 sc1 lds
    s_mov_b32 exec_hi, 0
    buffer_load_dwordx4 v92, s[40:43], s60 offen offset:2048 sc1 lds
    s_mov_b64 exec, -1
    s_waitcnt vmcnt(0)
    s_lshl_b32 s68, s49, 2
    v_add_u32 v88, s68, v102
    s_add_u32 s68, s53, 1
    v_mov_b32 v89, s68
    ds_write_b32 v88, v89 offset:64
    s_mov_b32 s67, 2
    s_nop 0
Lwf_33:
    ds_read_b128 v[72:75], v102 offset:128
    s_waitcnt lgkmcnt(0)
    v_min3_u32 v72, v72, v73, v74
    v_min_u32 v72, v72, v75
    s_nop 0
    v_readfirstlane_b32 s68, v72
    s_nop 1
    s_cmp_ge_u32 s68, s67
    s_nop 1
    s_cbranch_scc1 Lwfd_34
    s_sub_u32 s56, s56, 1
    s_cmp_eq_u32 s56, 0
    s_mov_b32 s69, 21
    s_cbranch_scc1 L_ABORT
    s_branch Lwf_33
Lwfd_34:
    v_and_b32 v76, 15, v103
    v_lshlrev_b32 v76, 4, v76
    v_add_u32 v77, 256, v76
    v_and_b32 v78, 16, v103
    s_cmp_eq_u32 s51, 0
    s_cselect_b32 s60, 0, 16
    v_and_b32 v78, s60, v78
    v_cmp_eq_u32 s[62:63], 0, v78
    s_nop 1
    v_cndmask_b32 v76, v76, v77, s[62:63]
    s_lshl_b32 s60, s51, 8
    s_add_u32 s60, s60, 21298944
    s_nop 0
Lini_35:
    buffer_load_dwordx4 v[72:75], v76, s[40:43], s60 offen sc1
    s_waitcnt vmcnt(0)
    v_xor_b32 v72, s58, v72
    v_xor_b32 v73, s59, v73
    v_xor_b32 v75, s58, v75
    v_or3_b32 v72, v72, v73, v75
    v_cmp_ne_u32 vcc, 0, v72
    s_nop 1
    s_cmp_eq_u64 vcc, 0
    s_nop 1
    s_cbranch_scc1 Linid_36
    s_sub_u32 s56, s56, 1
    s_cmp_eq_u32 s56, 0
    s_mov_b32 s69, 8
    s_cbranch_scc1 L_ABORT
    s_sleep 2
    s_branch Lini_35
Linid_36:
    v_cmp_ne_u32 vcc, s93, v74
    s_nop 1
    s_and_b64 vcc, vcc, s[62:63]
    s_cmp_eq_u64 vcc, 0
    s_cselect_b32 s85, 1, 0
    s_lshl_b32 s62, s50, 4
    s_add_u32 s62, s62, s52
    s_lshl_b32 s62, s62, 2
    s_add_u32 s62, s62, s49
    s_lshl_b32 s63, s62, 7
    s_add_u32 s63, s63, 21364736
    v_and_b32 v74, 15, v103
    v_lshlrev_b32 v74, 3, v74
    s_nop 2
Lpn_37:
    buffer_load_dwordx2 v[72:73], v74, s[40:43], s63 offen sc1
    s_waitcnt vmcnt(0)
    v_xor_b32 v72, s58, v72
    v_xor_b32 v73, s59, v73
    v_or_b32 v72, v72, v73
    v_cmp_ne_u32 vcc, 0, v72
    s_nop 1
    s_cmp_eq_u64 vcc, 0
    s_nop 1
    s_cbranch_scc1 Lpnd_38
    s_sub_u32 s56, s56, 1
    s_cmp_eq_u32 s56, 0
    s_mov_b32 s69, 15
    s_cbranch_scc1 L_ABORT
    s_sleep 2
    s_branch Lpn_37
Lpnd_38:
    s_mul_i32 s62, s62, 36864
    s_add_u32 s62, s62, 25952256
    v_lshlrev_b32 v74, 4, v103
    buffer_load_dwordx4 v[112:115], v74, s[40:43], s62 offen offset:0 sc1
    buffer_load_dwordx4 v[116:119], v74, s[40:43], s62 offen offset:1024 sc1
    buffer_load_dwordx4 v[120:123], v74, s[40:43], s62 offen offset:2048 sc1
    buffer_load_dwordx4 v[124:127], v74, s[40:43], s62 offen offset:3072 sc1
    s_add_u32 s62, s62, 4096
    buffer_load_dwordx4 v[128:131], v74, s[40:43], s62 offen offset:0 sc1
    buffer_load_dwordx4 v[132:135], v74, s[40:43], s62 offen offset:1024 sc1
    buffer_load_dwordx4 v[136:139], v74, s[40:43], s62 offen offset:2048 sc1
    buffer_load_dwordx4 v[140:143], v74, s[40:43], s62 offen offset:3072 sc1
    s_add_u32 s62, s62, 4096
    buffer_load_dwordx4 v[144:147], v74, s[40:43], s62 offen offset:0 sc1
    buffer_load_dwordx4 v[148:151], v74, s[40:43], s62 offen offset:1024 sc1
    buffer_load_dwordx4 v[152:155], v74, s[40:43], s62 offen offset:2048 sc1
    buffer_load_dwordx4 v[156:159], v74, s[40:43], s62 offen offset:3072 sc1
    s_add_u32 s62, s62, 4096
    buffer_load_dwordx4 v[160:163], v74, s[40:43], s62 offen offset:0 sc1
    buffer_load_dwordx4 v[164:167], v74, s[40:43], s62 offen offset:1024 sc1
    buffer_load_dwordx4 v[168:171], v74, s[40:43], s62 offen offset:2048 sc1
    buffer_load_dwordx4 v[172:175], v74, s[40:43], s62 offen offset:3072 sc1
    s_add_u32 s62, s62, 4096
    buffer_load_dwordx4 v[176:179], v74, s[40:43], s62 offen offset:0 sc1
    buffer_load_dwordx4 v[180:183], v74, s[40:43], s62 offen offset:1024 sc1
    buffer_load_dwordx4 v[184:187], v74, s[40:43], s62 offen offset:2048 sc1
    buffer_load_dwordx4 v[188:191], v74, s[40:43], s62 offen offset:3072 sc1
    s_add_u32 s62, s62, 4096
    buffer_load_dwordx4 v[192:195], v74, s[40:43], s62 offen offset:0 sc1
    buffer_load_dwordx4 v[196:199], v74, s[40:43], s62 offen offset:1024 sc1
    buffer_load_dwordx4 v[200:203], v74, s[40:43], s62 offen offset:2048 sc1
    buffer_load_dwordx4 v[204:207], v74, s[40:43], s62 offen offset:3072 sc1
    s_add_u32 s62, s62, 4096
    buffer_load_dwordx4 v[208:211], v74, s[40:43], s62 offen offset:0 sc1
    buffer_load_dwordx4 v[212:215], v74, s[40:43], s62 offen offset:1024 sc1
    buffer_load_dwordx4 v[216:219], v74, s[40:43], s62 offen offset:2048 sc1
    buffer_load_dwordx4 v[220:223], v74, s[40:43], s62 offen offset:3072 sc1
    s_add_u32 s62, s62, 4096
    buffer_load_dwordx4 v[224:227], v74, s[40:43], s62 offen offset:0 sc1
    buffer_load_dwordx4 v[228:231], v74, s[40:43], s62 offen offset:1024 sc1
    buffer_load_dwordx4 v[232:235], v74, s[40:43], s62 offen offset:2048 sc1
    buffer_load_dwordx4 v[236:239], v74, s[40:43], s62 offen offset:3072 sc1
    s_add_u32 s62, s62, 4096
    buffer_load_dwordx4 v[240:243], v74, s[40:43], s62 offen offset:0 sc1
    buffer_load_dwordx4 v[244:247], v74, s[40:43], s62 offen offset:1024 sc1
    buffer_load_dwordx4 v[248:251], v74, s[40:43], s62 offen offset:2048 sc1
    buffer_load_dwordx4 v[252:255], v74, s[40:43], s62 offen offset:3072 sc1
Lwf_39:
    ds_read_b128 v[88:91], v102 offset:16
    s_waitcnt lgkmcnt(0)
    v_min3_u32 v88, v88, v89, v90
    v_min_u32 v88, v88, v91
    s_nop 0
    v_readfirstlane_b32 s68, v88
    s_nop 1
    s_cmp_ge_u32 s68, s55
    s_nop 1
    s_cbranch_scc1 Lwfd_40
    s_sub_u32 s56, s56, 1
    s_cmp_eq_u32 s56, 0
    s_mov_b32 s69, 6
    s_cbranch_scc1 L_ABORT
    s_branch Lwf_39
Lwfd_40:
    s_waitcnt vmcnt(50)
    ds_write_b128 v85, v[0:3] offset:0
    ds_write_b128 v85, v[4:7] offset:1024
    ds_write_b128 v85, v[8:11] offset:2048
    ds_write_b128 v85, v[12:15] offset:3072
    ds_write_b128 v85, v[16:19] offset:4096
    ds_write_b128 v85, v[20:23] offset:5120
    s_waitcnt vmcnt(44)
    ds_write_b128 v85, v[24:27] offset:6144
    ds_write_b128 v85, v[28:31] offset:7168
    ds_write_b128 v85, v[32:35] offset:8192
    ds_write_b128 v85, v[36:39] offset:9216
    ds_write_b128 v85, v[40:43] offset:10240
    ds_write_b128 v85, v[44:47] offset:11264
    s_waitcnt vmcnt(36)
    ds_write_b128 v85, v[48:51] offset:12288
    ds_write_b128 v85, v[52:55] offset:13312
    ds_write_b128 v85, v[56:59] offset:14336
    ds_write_b128 v85, v[60:63] offset:15360
    ds_write_b64 v87, v[64:65] offset:16384
    ds_write_b64 v87, v[66:67] offset:16896
    ds_write_b64 v87, v[68:69] offset:17408
    ds_write_b64 v87, v[70:71] offset:17920
    v_dot2_f32_bf16 v88, v0, v0, 0
    v_dot2_f32_bf16 v89, v1, v1, 0
    v_dot2_f32_bf16 v88, v2, v2, v88
    v_dot2_f32_bf16 v89, v3, v3, v89
    v_dot2_f32_bf16 v88, v4, v4, v88
    v_dot2_f32_bf16 v89, v5, v5, v89
    v_dot2_f32_bf16 v88, v6, v6, v88
    v_dot2_f32_bf16 v89, v7, v7, v89
    v_dot2_f32_bf16 v88, v8, v8, v88
    v_dot2_f32_bf16 v89, v9, v9, v89
    v_dot2_f32_bf16 v88, v10, v10, v88
    v_dot2_f32_bf16 v89, v11, v11, v89
    v_dot2_f32_bf16 v88, v12, v12, v88
    v_dot2_f32_bf16 v89, v13, v13, v89
    v_dot2_f32_bf16 v88, v14, v14, v88
    v_dot2_f32_bf16 v89, v15, v15, v89
    v_dot2_f32_bf16 v88, v16, v16, v88
    v_dot2_f32_bf16 v89, v17, v17, v89
    v_dot2_f32_bf16 v88, v18, v18, v88
    v_dot2_f32_bf16 v89, v19, v19, v89
    v_dot2_f32_bf16 v88, v20, v20, v88
    v_dot2_f32_bf16 v89, v21, v21, v89
    v_dot2_f32_bf16 v88, v22, v22, v88
    v_dot2_f32_bf16 v89, v23, v23, v89
    v_dot2_f32_bf16 v88, v24, v24, v88
    v_dot2_f32_bf16 v89, v25, v25, v89
    v_dot2_f32_bf16 v88, v26, v26, v88
    v_dot2_f32_bf16 v89, v27, v27, v89
    v_dot2_f32_bf16 v88, v28, v28, v88
    v_dot2_f32_bf16 v89, v29, v29, v89
    v_dot2_f32_bf16 v88, v30, v30, v88
    v_dot2_f32_bf16 v89, v31, v31, v89
    v_dot2_f32_bf16 v88, v32, v32, v88
    v_dot2_f32_bf16 v89, v33, v33, v89
    v_dot2_f32_bf16 v88, v34, v34, v88
    v_dot2_f32_bf16 v89, v35, v35, v89
    v_dot2_f32_bf16 v88, v36, v36, v88
    v_dot2_f32_bf16 v89, v37, v37, v89
    v_dot2_f32_bf16 v88, v38, v38, v88
    v_dot2_f32_bf16 v89, v39, v39, v89
    v_dot2_f32_bf16 v88, v40, v40, v88
    v_dot2_f32_bf16 v89, v41, v41, v89
    v_dot2_f32_bf16 v88, v42, v42, v88
    v_dot2_f32_bf16 v89, v43, v43, v89
    v_dot2_f32_bf16 v88, v44, v44, v88
    v_dot2_f32_bf16 v89, v45, v45, v89
    v_dot2_f32_bf16 v88, v46, v46, v88
    v_dot2_f32_bf16 v89, v47, v47, v89
    v_dot2_f32_bf16 v88, v48, v48, v88
    v_dot2_f32_bf16 v89, v49, v49, v89
    v_dot2_f32_bf16 v88, v50, v50, v88
    v_dot2_f32_bf16 v89, v51, v51, v89
    v_dot2_f32_bf16 v88, v52, v52, v88
    v_dot2_f32_bf16 v89, v53, v53, v89
    v_dot2_f32_bf16 v88, v54, v54, v88
    v_dot2_f32_bf16 v89, v55, v55, v89
    v_dot2_f32_bf16 v88, v56, v56, v88
    v_dot2_f32_bf16 v89, v57, v57, v89
    v_dot2_f32_bf16 v88, v58, v58, v88
    v_dot2_f32_bf16 v89, v59, v59, v89
    v_dot2_f32_bf16 v88, v60, v60, v88
    v_dot2_f32_bf16 v89, v61, v61, v89
    v_dot2_f32_bf16 v88, v62, v62, v88
    v_dot2_f32_bf16 v89, v63, v63, v89
    v_dot2_f32_bf16 v88, v64, v64, v88
    v_dot2_f32_bf16 v89, v65, v65, v89
    v_dot2_f32_bf16 v88, v66, v66, v88
    v_dot2_f32_bf16 v89, v67, v67, v89
    v_dot2_f32_bf16 v88, v68, v68, v88
    v_dot2_f32_bf16 v89, v69, v69, v89
    v_dot2_f32_bf16 v88, v70, v70, v88
    v_dot2_f32_bf16 v89, v71, v71, v89
    s_nop 2
    v_add_f32 v88, v88, v89
    v_mov_b32 v89, 0
    v_subrev_u32 v90, s4, v87
    v_lshrrev_b32 v90, 1, v90
    v_add_u32 v90, s4, v90
    ds_write_b32 v90, v88 offset:18432
    ds_write_b32 v90, v89 offset:18688
    ds_write_b32 v90, v89 offset:18944
    ds_write_b32 v90, v89 offset:19200
    s_waitcnt lgkmcnt(0)
    s_lshl_b32 s68, s49, 2
    v_add_u32 v88, s68, v102
    s_add_u32 s68, s57, 4
    v_mov_b32 v89, s68
    ds_write_b32 v88, v89 offset:0
    s_mov_b32 s54, 0
    s_nop 0
    s_branch L_BPHASE
L_M_ROLE:
    s_mov_b32 s54, 0
L_M_TASK:
    s_lshl_b32 s55, s53, 1
    s_add_u32 s55, s55, s54
    s_lshl_b32 s57, s55, 2
    v_lshrrev_b32 v40, 4, v103
    v_and_b32 v41, 15, v103
    v_and_b32 v42, 1, v40
    v_lshlrev_b32 v42, 1, v42
    v_lshrrev_b32 v95, 1, v40
    v_mul_u32_u24 v95, 12, v95
    v_add_u32 v42, v42, v95
    v_xor_b32 v42, v42, v41
    v_lshlrev_b32 v42, 4, v42
    v_lshl_add_u32 v95, v40, 8, v42
    v_add_u32 v96, 38912, v95
    v_lshlrev_b32 v41, 3, v41
    v_lshl_add_u32 v97, v40, 8, v41
    v_add_u32 v97, 16384, v97
    s_nop 2
L_M_GO:
    s_cmp_eq_u32 s13, 0
    s_cbranch_scc1 Lown_41
    s_waitcnt vmcnt(15)
    s_lshl_b32 s68, s49, 2
    v_add_u32 v40, s68, v102
    s_add_u32 s68, s57, 1
    v_mov_b32 v41, s68
    ds_write_b32 v40, v41 offset:0
    s_nop 1
Lown_41:
    s_lshl_b32 s83, s53, 5
    s_lshl_b32 s61, s51, 1
    s_add_u32 s83, s83, s61
    s_add_u32 s83, s83, s54
    s_lshl_b32 s83, s83, 4
    s_add_u32 s83, s83, s52
    s_mul_i32 s83, s83, 2304
    s_add_u32 s83, s83, 14155776
    s_sub_u32 s84, s83, 73728
    s_add_u32 s67, s57, 1
    ds_read_b128 v[40:43], v102 offset:0
    s_waitcnt lgkmcnt(0)
    v_min3_u32 v40, v40, v41, v42
    v_min_u32 v40, v40, v43
    s_nop 0
    v_readfirstlane_b32 s68, v40
    s_nop 1
    s_cmp_ge_u32 s68, s67
    s_nop 1
    s_cbranch_scc1 Lrdy_42
    s_cmp_eq_u32 s7, 0
    s_cbranch_scc1 Lnopub_43
    s_mov_b32 s7, 0
    s_mov_b32 s54, 0
    s_cmp_eq_u32 s85, 0
    s_cbranch_scc1 Lslow_44
    s_lshl_b32 s60, s54, 9
    s_add_u32 s60, s60, s12
    s_lshl_b32 s61, s52, 3
    s_add_u32 s60, s60, s61
    s_add_u32 s61, s58, s53
    s_add_u32 s61, s61, 1
    v_mov_b32 v44, s61
    v_mov_b32 v45, s59
    v_mov_b32 v46, 0
    s_mov_b64 exec, 1
    s_waitcnt vmcnt(0)
    buffer_store_dwordx2 v[44:45], v46, s[40:43], s60 offen
    s_mov_b64 exec, -1
    s_branch Lmend_45
Lslow_44:
    s_lshl_b32 s60, s54, 9
    s_add_u32 s60, s60, s12
    s_lshl_b32 s61, s52, 3
    s_add_u32 s60, s60, s61
    s_add_u32 s61, s58, s53
    s_add_u32 s61, s61, 1
    v_mov_b32 v44, s61
    v_mov_b32 v45, s59
    v_mov_b32 v46, 0
    s_mov_b64 exec, 1
    s_waitcnt vmcnt(0)
    buffer_store_dwordx2 v[44:45], v46, s[40:43], s60 offen sc1
    s_mov_b64 exec, -1
Lmend_45:
    s_mov_b32 s54, 1
Lnopub_43:
Lwf_46:
    ds_read_b128 v[40:43], v102 offset:0
    s_waitcnt lgkmcnt(0)
    v_min3_u32 v40, v40, v41, v42
    v_min_u32 v40, v40, v43
    s_nop 0
    v_readfirstlane_b32 s68, v40
    s_nop 1
    s_cmp_ge_u32 s68, s67
    s_nop 1
    s_cbranch_scc1 Lwfd_47
    s_sub_u32 s56, s56, 1
    s_cmp_eq_u32 s56, 0
    s_mov_b32 s69, 1
    s_cbranch_scc1 L_ABORT
    s_branch Lwf_46
Lwfd_47:
Lrdy_42:
    s_setprio 0
    s_cmp_eq_u32 s49, 1
    s_cbranch_scc1 L_A_W1
    s_cmp_eq_u32 s49, 2
    s_cbranch_scc1 L_A_W2
    s_cmp_eq_u32 s49, 3
    s_cbranch_scc1 L_A_W3
L_A_W0:
    v_add_u32 v98, 58368, v97
    ds_read_b128 v[40:43], v96 offset:19456
    ds_read_b128 v[44:47], v96 offset:20480
    ds_read_b128 v[48:51], v96 offset:21504
    ds_read_b128 v[52:55], v96 offset:22528
    ds_read_b128 v[56:59], v96 offset:23552
    ds_read_b128 v[60:63], v96 offset:24576
    ds_read_b128 v[64:67], v96 offset:25600
    s_waitcnt lgkmcnt(5)
    v_mfma_f32_16x16x32_bf16 v[0:3], v[112:115], v[40:43], 0
    v_and_b32 v74, 15, v103
    v_add_u32 v73, 48, v74
    v_mfma_f32_16x16x32_bf16 v[4:7], v[116:119], v[40:43], 0
    ds_read_b128 v[68:71], v96 offset:26624
    v_lshlrev_b32 v73, 2, v73
    v_mfma_f32_16x16x32_bf16 v[0:3], v[120:123], v[44:47], v[0:3]
    s_add_u32 s66, s57, 2
    v_mov_b32 v99, s66
    v_mfma_f32_16x16x32_bf16 v[4:7], v[124:127], v[44:47], v[4:7]
    ds_read_b128 v[40:43], v96 offset:27648
    s_waitcnt lgkmcnt(5)
    v_mfma_f32_16x16x32_bf16 v[0:3], v[128:131], v[48:51], v[0:3]
    s_cmp_eq_u32 s13, 0
    s_cbranch_scc1 Lop_48
    s_waitcnt vmcnt(10)
    ds_write_b32 v102, v99 offset:0
Lop_48:
    v_lshrrev_b32 v75, 4, v103
    v_mfma_f32_16x16x32_bf16 v[4:7], v[132:135], v[48:51], v[4:7]
    ds_read_b128 v[44:47], v96 offset:28672
    v_lshlrev_b32 v75, 3, v75
    v_mfma_f32_16x16x32_bf16 v[0:3], v[136:139], v[52:55], v[0:3]
    s_mov_b32 s65, 0x50801000
    v_bfe_u32 v72, s65, v75, 8
    v_mfma_f32_16x16x32_bf16 v[4:7], v[140:143], v[52:55], v[4:7]
    ds_read_b128 v[48:51], v96 offset:29696
    s_waitcnt lgkmcnt(5)
    v_mfma_f32_16x16x32_bf16 v[0:3], v[144:147], v[56:59], v[0:3]
    v_mul_u32_u24 v74, 272, v74
    v_add_u32 v74, 0x13000, v74
    v_mfma_f32_16x16x32_bf16 v[4:7], v[148:151], v[56:59], v[4:7]
    ds_read_b128 v[52:55], v96 offset:30720
    v_add_u32 v72, v72, v74
    v_mfma_f32_16x16x32_bf16 v[0:3], v[152:155], v[60:63], v[0:3]
    s_cmp_eq_u32 s7, 0
    s_cbranch_scc1 Lnopub_49
    s_mov_b32 s7, 0
    s_mov_b32 s54, 0
    s_cmp_eq_u32 s85, 0
    s_nop 3
    s_cbranch_scc1 Lslow_50
    s_lshl_b32 s60, s54, 9
    s_add_u32 s60, s60, s12
    s_lshl_b32 s61, s52, 3
    s_add_u32 s60, s60, s61
    s_add_u32 s61, s58, s53
    s_add_u32 s61, s61, 1
    v_mov_b32 v92, s61
    v_mov_b32 v93, s59
    v_mov_b32 v94, 0
    s_mov_b64 exec, 1
    s_waitcnt vmcnt(0)
    buffer_store_dwordx2 v[92:93], v94, s[40:43], s60 offen
    s_mov_b64 exec, -1
    s_branch Lmend_51
Lslow_50:
    s_lshl_b32 s60, s54, 9
    s_add_u32 s60, s60, s12
    s_lshl_b32 s61, s52, 3
    s_add_u32 s60, s60, s61
    s_add_u32 s61, s58, s53
    s_add_u32 s61, s61, 1
    v_mov_b32 v92, s61
    v_mov_b32 v93, s59
    v_mov_b32 v94, 0
    s_mov_b64 exec, 1
    s_waitcnt vmcnt(0)
    buffer_store_dwordx2 v[92:93], v94, s[40:43], s60 offen sc1
    s_mov_b64 exec, -1
Lmend_51:
    s_mov_b32 s54, 1
Lnopub_49:
    ds_read_b128 v[36:39], v102 offset:0
    v_mfma_f32_16x16x32_bf16 v[4:7], v[156:159], v[60:63], v[4:7]
    ds_read_b128 v[56:59], v96 offset:31744
    s_waitcnt lgkmcnt(6)
    v_mfma_f32_16x16x32_bf16 v[0:3], v[160:163], v[64:67], v[0:3]
    v_mfma_f32_16x16x32_bf16 v[4:7], v[164:167], v[64:67], v[4:7]
    ds_read_b128 v[60:63], v96 offset:32768
    v_mfma_f32_16x16x32_bf16 v[0:3], v[168:171], v[68:71], v[0:3]
    s_add_u32 s67, s57, 2
    s_waitcnt lgkmcnt(2)
    v_min3_u32 v36, v36, v37, v38
    v_mfma_f32_16x16x32_bf16 v[4:7], v[172:175], v[68:71], v[4:7]
    ds_read_b128 v[64:67], v96 offset:33792
    s_waitcnt lgkmcnt(6)
    v_mfma_f32_16x16x32_bf16 v[0:3], v[176:179], v[40:43], v[0:3]
    v_min_u32 v36, v36, v39
    v_mfma_f32_16x16x32_bf16 v[4:7], v[180:183], v[40:43], v[4:7]
    ds_read_b128 v[68:71], v96 offset:34816
    v_readfirstlane_b32 s68, v36
    v_mfma_f32_16x16x32_bf16 v[0:3], v[184:187], v[44:47], v[0:3]
    s_add_u32 s66, s57, 3
    v_mfma_f32_16x16x32_bf16 v[4:7], v[188:191], v[44:47], v[4:7]
    ds_read2_b64 v[40:43], v98 offset0:0 offset1:16
    s_waitcnt lgkmcnt(6)
    v_mfma_f32_16x16x32_bf16 v[0:3], v[192:195], v[48:51], v[0:3]
    v_mov_b32 v99, s66
    s_cmp_ge_u32 s68, s67
    s_cbranch_scc1 Lck_52
    s_nop 5
Lwf_53:
    ds_read_b128 v[36:39], v102 offset:0
    s_waitcnt lgkmcnt(0)
    v_min3_u32 v36, v36, v37, v38
    v_min_u32 v36, v36, v39
    s_nop 0
    v_readfirstlane_b32 s68, v36
    s_nop 1
    s_cmp_ge_u32 s68, s67
    s_nop 1
    s_cbranch_scc1 Lwfd_54
    s_sub_u32 s56, s56, 1
    s_cmp_eq_u32 s56, 0
    s_mov_b32 s69, 2
    s_cbranch_scc1 L_ABORT
    s_branch Lwf_53
Lwfd_54:
Lck_52:
    s_cmp_eq_u32 s13, 0
    s_cbranch_scc1 Lop_55
    s_waitcnt vmcnt(5)
    ds_write_b32 v102, v99 offset:0
Lop_55:
    v_mfma_f32_16x16x32_bf16 v[4:7], v[196:199], v[48:51], v[4:7]
    ds_read2_b64 v[44:47], v98 offset0:128 offset1:144
    v_lshrrev_b32 v32, 4, v103
    v_mfma_f32_16x16x32_bf16 v[0:3], v[200:203], v[52:55], v[0:3]
    v_lshl_add_u32 v32, v32, 8, v73
    v_add_u32 v32, 0x12b40, v32
    v_mfma_f32_16x16x32_bf16 v[4:7], v[204:207], v[52:55], v[4:7]
    ds_read_b128 v[48:51], v95 offset:19456
    s_waitcnt lgkmcnt(5)
    v_mfma_f32_16x16x32_bf16 v[0:3], v[208:211], v[56:59], v[0:3]
    ds_read2_b32 v[34:35], v32 offset0:32 offset1:48
    ds_read2_b32 v[32:33], v32 offset0:0 offset1:16
    v_mfma_f32_16x16x32_bf16 v[4:7], v[212:215], v[56:59], v[4:7]
    ds_read_b128 v[52:55], v95 offset:20480
    v_mfma_f32_16x16x32_bf16 v[0:3], v[216:219], v[60:63], v[0:3]
    v_mfma_f32_16x16x32_bf16 v[4:7], v[220:223], v[60:63], v[4:7]
    ds_read_b128 v[56:59], v95 offset:21504
    s_waitcnt lgkmcnt(7)
    v_mfma_f32_16x16x32_bf16 v[0:3], v[224:227], v[64:67], v[0:3]
    ds_read_b128 v[36:39], v102 offset:48
    s_waitcnt lgkmcnt(3)
    v_add_f32 v32, v32, v33
    v_mfma_f32_16x16x32_bf16 v[4:7], v[228:231], v[64:67], v[4:7]
    ds_read_b128 v[60:63], v95 offset:22528
    v_add_f32 v34, v34, v35
    v_mfma_f32_16x16x32_bf16 v[0:3], v[232:235], v[68:71], v[0:3]
    v_add_f32 v32, v32, v34
    v_mov_b32 v33, v32
    s_mov_b32 s67, s55
    v_mfma_f32_16x16x32_bf16 v[4:7], v[236:239], v[68:71], v[4:7]
    ds_read_b128 v[64:67], v95 offset:23552
    s_waitcnt lgkmcnt(8)
    v_mfma_f32_16x16x32_bf16 v[0:3], v[240:243], v[40:43], v[0:3]
    v_permlane32_swap_b32 v32, v33
    s_add_u32 s66, s57, 4
    s_waitcnt lgkmcnt(2)
    v_min3_u32 v36, v36, v37, v38
    v_add_f32 v32, v32, v33
    v_mov_b32 v99, s66
    v_min_u32 v36, v36, v39
    v_mov_b32 v33, v32
    s_cmp_eq_u32 s13, 0
    s_cbranch_scc1 Lop_56
    s_waitcnt vmcnt(0)
    ds_write_b32 v102, v99 offset:0
Lop_56:
    v_mfma_f32_16x16x32_bf16 v[4:7], v[244:247], v[40:43], v[4:7]
    ds_read_b128 v[68:71], v95 offset:24576
    v_permlane16_swap_b32 v32, v33
    v_mfma_f32_16x16x32_bf16 v[0:3], v[248:251], v[44:47], v[0:3]
    v_readfirstlane_b32 s68, v36
    v_add_f32 v32, v32, v33
    v_mul_f32 v32, 0x3ae38e39, v32
    s_cmp_ge_u32 s68, s67
    s_cbranch_scc1 Lck_57
    s_nop 3
Lwf_58:
    ds_read_b128 v[36:39], v102 offset:48
    s_waitcnt lgkmcnt(0)
    v_min3_u32 v36, v36, v37, v38
    v_min_u32 v36, v36, v39
    s_nop 0
    v_readfirstlane_b32 s68, v36
    s_nop 1
    s_cmp_ge_u32 s68, s67
    s_nop 1
    s_cbranch_scc1 Lwfd_59
    s_sub_u32 s56, s56, 1
    s_cmp_eq_u32 s56, 0
    s_mov_b32 s69, 3
    s_cbranch_scc1 L_ABORT
    s_branch Lwf_58
Lwfd_59:
Lck_57:
    v_mfma_f32_16x16x32_bf16 v[4:7], v[252:255], v[44:47], v[4:7]
    ds_read_b128 v[40:43], v95 offset:25600
    s_waitcnt lgkmcnt(6)
    v_mfma_f32_16x16x32_bf16 v[8:11], v[112:115], v[48:51], 0
    v_mfma_f32_16x16x32_bf16 v[12:15], v[116:119], v[48:51], 0
    ds_read_b128 v[44:47], v95 offset:26624
    v_mfma_f32_16x16x32_bf16 v[8:11], v[120:123], v[52:55], v[8:11]
    v_mfma_f32_16x16x32_bf16 v[12:15], v[124:127], v[52:55], v[12:15]
    ds_read_b128 v[48:51], v95 offset:27648
    s_waitcnt lgkmcnt(5)
    v_mfma_f32_16x16x32_bf16 v[8:11], v[128:131], v[56:59], v[8:11]
    v_mfma_f32_16x16x32_bf16 v[12:15], v[132:135], v[56:59], v[12:15]
    ds_read_b128 v[52:55], v95 offset:28672
    v_mfma_f32_16x16x32_bf16 v[8:11], v[136:139], v[60:63], v[8:11]
    ds_bpermute_b32 v74, v73, v2
    v_add_u32 v34, 0x22740, v73
    s_waitcnt lgkmcnt(0)
    v_mul_f32 v74, 0xbae38e39, v74
    v_mfma_f32_16x16x32_bf16 v[12:15], v[140:143], v[60:63], v[12:15]
    ds_read_b128 v[56:59], v95 offset:29696
    s_waitcnt lgkmcnt(6)
    v_mfma_f32_16x16x32_bf16 v[8:11], v[144:147], v[64:67], v[8:11]
    v_fma_f32 v0, v74, v104, v0
    v_fma_f32 v1, v74, v105, v1
    v_fma_f32 v2, v74, v106, v2
    v_mfma_f32_16x16x32_bf16 v[12:15], v[148:151], v[64:67], v[12:15]
    ds_read_b128 v[60:63], v95 offset:30720
    v_fma_f32 v3, v74, v107, v3
    v_mfma_f32_16x16x32_bf16 v[8:11], v[152:155], v[68:71], v[8:11]
    v_fma_f32 v4, v74, v108, v4
    v_fma_f32 v5, v74, v109, v5
    v_mfma_f32_16x16x32_bf16 v[12:15], v[156:159], v[68:71], v[12:15]
    ds_read_b128 v[64:67], v95 offset:31744
    s_waitcnt lgkmcnt(6)
    v_mfma_f32_16x16x32_bf16 v[8:11], v[160:163], v[40:43], v[8:11]
    v_fma_f32 v6, v74, v110, v6
    v_fma_f32 v7, v74, v111, v7
    v_cvt_pk_bf16_f32 v0, v0, v4
    v_mfma_f32_16x16x32_bf16 v[12:15], v[164:167], v[40:43], v[12:15]
    ds_read_b128 v[68:71], v95 offset:32768
    v_cvt_pk_bf16_f32 v1, v1, v5
    v_mfma_f32_16x16x32_bf16 v[8:11], v[168:171], v[44:47], v[8:11]
    ds_read_b128 v[36:39], v102 offset:0
    v_cvt_pk_bf16_f32 v2, v2, v6
    v_cvt_pk_bf16_f32 v3, v3, v7
    v_mfma_f32_16x16x32_bf16 v[12:15], v[172:175], v[44:47], v[12:15]
    ds_read_b128 v[40:43], v95 offset:33792
    s_waitcnt lgkmcnt(7)
    v_mfma_f32_16x16x32_bf16 v[8:11], v[176:179], v[48:51], v[8:11]
    ds_write_b128 v72, v[0:3] offset:17408
    v_fma_f32 v32, -v74, v74, v32
    s_add_u32 s67, s57, 3
    v_max_f32 v32, 0, v32
    v_mfma_f32_16x16x32_bf16 v[12:15], v[180:183], v[48:51], v[12:15]
    ds_read_b128 v[44:47], v95 offset:34816
    s_waitcnt lgkmcnt(3)
    v_min3_u32 v36, v36, v37, v38
    v_mfma_f32_16x16x32_bf16 v[8:11], v[184:187], v[52:55], v[8:11]
    v_add_f32 v32, 0x3727c5ac, v32
    v_min_u32 v36, v36, v39
    v_rsq_f32 v32, v32
    s_mov_b64 exec, 0xffff
    ds_write_b32 v34, v32
    s_mov_b64 exec, 0xff00
    buffer_store_dword v32, v73, s[40:43], s83 offen offset:1824 sc1
    s_mov_b64 exec, -1
    v_mfma_f32_16x16x32_bf16 v[12:15], v[188:191], v[52:55], v[12:15]
    v_add_u32 v98, 19456, v97
    ds_read2_b64 v[48:51], v98 offset0:0 offset1:16
    s_waitcnt lgkmcnt(8)
    v_mfma_f32_16x16x32_bf16 v[8:11], v[192:195], v[56:59], v[8:11]
    v_readfirstlane_b32 s68, v36
    s_cmp_ge_u32 s68, s67
    s_cbranch_scc1 Lck_60
    s_nop 5
Lwf_61:
    ds_read_b128 v[36:39], v102 offset:0
    s_waitcnt lgkmcnt(0)
    v_min3_u32 v36, v36, v37, v38
    v_min_u32 v36, v36, v39
    s_nop 0
    v_readfirstlane_b32 s68, v36
    s_nop 1
    s_cmp_ge_u32 s68, s67
    s_nop 1
    s_cbranch_scc1 Lwfd_62
    s_sub_u32 s56, s56, 1
    s_cmp_eq_u32 s56, 0
    s_mov_b32 s69, 2
    s_cbranch_scc1 L_ABORT
    s_branch Lwf_61
Lwfd_62:
Lck_60:
    v_mfma_f32_16x16x32_bf16 v[12:15], v[196:199], v[56:59], v[12:15]
    ds_read2_b64 v[52:55], v98 offset0:128 offset1:144
    v_mfma_f32_16x16x32_bf16 v[8:11], v[200:203], v[60:63], v[8:11]
    v_mfma_f32_16x16x32_bf16 v[12:15], v[204:207], v[60:63], v[12:15]
    ds_read_b128 v[56:59], v96 offset:0
    s_waitcnt lgkmcnt(8)
    v_mfma_f32_16x16x32_bf16 v[8:11], v[208:211], v[64:67], v[8:11]
    v_lshlrev_b32 v88, 4, v103
    v_and_b32 v89, 7, v103
    v_mfma_f32_16x16x32_bf16 v[12:15], v[212:215], v[64:67], v[12:15]
    ds_read_b128 v[60:63], v96 offset:1024
    v_lshlrev_b32 v89, 2, v89
    v_mfma_f32_16x16x32_bf16 v[8:11], v[216:219], v[68:71], v[8:11]
    v_add_u32 v91, 0x22720, v89
    v_mov_b32 v90, 0x7f000000
    v_mfma_f32_16x16x32_bf16 v[12:15], v[220:223], v[68:71], v[12:15]
    ds_read_b128 v[64:67], v96 offset:2048
    s_waitcnt lgkmcnt(6)
    v_mfma_f32_16x16x32_bf16 v[8:11], v[224:227], v[40:43], v[8:11]
    s_cmp_eq_u32 s51, 0
    s_cselect_b64 vcc, -1, 0
    v_cndmask_b32 v88, v88, v90, vcc
    v_cndmask_b32 v89, v89, v90, vcc
    v_mfma_f32_16x16x32_bf16 v[12:15], v[228:231], v[40:43], v[12:15]
    ds_read_b128 v[68:71], v96 offset:3072
    v_mfma_f32_16x16x32_bf16 v[8:11], v[232:235], v[44:47], v[8:11]
    v_mfma_f32_16x16x32_bf16 v[12:15], v[236:239], v[44:47], v[12:15]
    ds_read_b128 v[40:43], v96 offset:4096
    s_waitcnt lgkmcnt(5)
    v_mfma_f32_16x16x32_bf16 v[8:11], v[240:243], v[48:51], v[8:11]
    v_mfma_f32_16x16x32_bf16 v[12:15], v[244:247], v[48:51], v[12:15]
    ds_read_b128 v[44:47], v96 offset:5120
    v_mfma_f32_16x16x32_bf16 v[8:11], v[248:251], v[52:55], v[8:11]
    v_mfma_f32_16x16x32_bf16 v[12:15], v[252:255], v[52:55], v[12:15]
    ds_read_b128 v[48:51], v96 offset:6144
    s_waitcnt lgkmcnt(5)
    v_mfma_f32_16x16x32_bf16 v[16:19], v[112:115], v[56:59], 0
    v_mfma_f32_16x16x32_bf16 v[20:23], v[116:119], v[56:59], 0
    ds_read_b128 v[52:55], v96 offset:7168
    v_mfma_f32_16x16x32_bf16 v[16:19], v[120:123], v[60:63], v[16:19]
    v_mfma_f32_16x16x32_bf16 v[20:23], v[124:127], v[60:63], v[20:23]
    ds_read_b128 v[56:59], v96 offset:8192
    s_waitcnt lgkmcnt(5)
    v_mfma_f32_16x16x32_bf16 v[16:19], v[128:131], v[64:67], v[16:19]
    v_mfma_f32_16x16x32_bf16 v[20:23], v[132:135], v[64:67], v[20:23]
    ds_read_b128 v[60:63], v96 offset:9216
    v_mfma_f32_16x16x32_bf16 v[16:19], v[136:139], v[68:71], v[16:19]
    ds_read_b128 v[36:39], v102 offset:0
    v_mfma_f32_16x16x32_bf16 v[20:23], v[140:143], v[68:71], v[20:23]
    ds_read_b128 v[64:67], v96 offset:10240
    s_waitcnt lgkmcnt(6)
    v_mfma_f32_16x16x32_bf16 v[16:19], v[144:147], v[40:43], v[16:19]
    v_mfma_f32_16x16x32_bf16 v[20:23], v[148:151], v[40:43], v[20:23]
    ds_read_b128 v[68:71], v96 offset:11264
    s_add_u32 s67, s57, 4
    v_mfma_f32_16x16x32_bf16 v[16:19], v[152:155], v[44:47], v[16:19]
    s_waitcnt lgkmcnt(2)
    v_min3_u32 v36, v36, v37, v38
    v_min_u32 v36, v36, v39
    v_mfma_f32_16x16x32_bf16 v[20:23], v[156:159], v[44:47], v[20:23]
    ds_read_b128 v[40:43], v96 offset:12288
    s_waitcnt lgkmcnt(6)
    v_mfma_f32_16x16x32_bf16 v[16:19], v[160:163], v[48:51], v[16:19]
    v_readfirstlane_b32 s68, v36
    v_mfma_f32_16x16x32_bf16 v[20:23], v[164:167], v[48:51], v[20:23]
    ds_read_b128 v[44:47], v96 offset:13312
    v_mfma_f32_16x16x32_bf16 v[16:19], v[168:171], v[52:55], v[16:19]
    s_cmp_ge_u32 s68, s67
    s_cbranch_scc1 Lck_63
    s_nop 6
Lwf_64:
    ds_read_b128 v[36:39], v102 offset:0
    s_waitcnt lgkmcnt(0)
    v_min3_u32 v36, v36, v37, v38
    v_min_u32 v36, v36, v39
    s_nop 0
    v_readfirstlane_b32 s68, v36
    s_nop 1
    s_cmp_ge_u32 s68, s67
    s_nop 1
    s_cbranch_scc1 Lwfd_65
    s_sub_u32 s56, s56, 1
    s_cmp_eq_u32 s56, 0
    s_mov_b32 s69, 2
    s_cbranch_scc1 L_ABORT
    s_branch Lwf_64
Lwfd_65:
Lck_63:
    ds_bpermute_b32 v74, v73, v10
    v_mfma_f32_16x16x32_bf16 v[20:23], v[172:175], v[52:55], v[20:23]
    ds_read_b128 v[48:51], v96 offset:14336
    s_waitcnt lgkmcnt(7)
    v_mfma_f32_16x16x32_bf16 v[16:19], v[176:179], v[56:59], v[16:19]
    v_mfma_f32_16x16x32_bf16 v[20:23], v[180:183], v[56:59], v[20:23]
    ds_read_b128 v[52:55], v96 offset:15360
    v_mfma_f32_16x16x32_bf16 v[16:19], v[184:187], v[60:63], v[16:19]
    s_waitcnt lgkmcnt(2)
    v_mul_f32 v74, 0xbae38e39, v74
    v_mfma_f32_16x16x32_bf16 v[20:23], v[188:191], v[60:63], v[20:23]
    v_add_u32 v98, 38912, v97
    ds_read2_b64 v[56:59], v98 offset0:0 offset1:16
    s_waitcnt lgkmcnt(6)
    v_mfma_f32_16x16x32_bf16 v[16:19], v[192:195], v[64:67], v[16:19]
    v_fma_f32 v8, v74, v104, v8
    v_fma_f32 v9, v74, v105, v9
    v_mfma_f32_16x16x32_bf16 v[20:23], v[196:199], v[64:67], v[20:23]
    ds_read2_b64 v[60:63], v98 offset0:128 offset1:144
    v_fma_f32 v10, v74, v106, v10
    v_mfma_f32_16x16x32_bf16 v[16:19], v[200:203], v[68:71], v[16:19]
    v_fma_f32 v11, v74, v107, v11
    v_fma_f32 v12, v74, v108, v12
    v_mfma_f32_16x16x32_bf16 v[20:23], v[204:207], v[68:71], v[20:23]
    ds_read_b128 v[64:67], v95 offset:0
    s_waitcnt lgkmcnt(6)
    v_mfma_f32_16x16x32_bf16 v[16:19], v[208:211], v[40:43], v[16:19]
    v_fma_f32 v13, v74, v109, v13
    v_fma_f32 v14, v74, v110, v14
    v_mfma_f32_16x16x32_bf16 v[20:23], v[212:215], v[40:43], v[20:23]
    ds_read_b128 v[68:71], v95 offset:1024
    v_fma_f32 v15, v74, v111, v15
    v_mfma_f32_16x16x32_bf16 v[16:19], v[216:219], v[44:47], v[16:19]
    v_cvt_pk_bf16_f32 v8, v8, v12
    v_cvt_pk_bf16_f32 v9, v9, v13
    v_mfma_f32_16x16x32_bf16 v[20:23], v[220:223], v[44:47], v[20:23]
    ds_read_b128 v[40:43], v95 offset:2048
    s_waitcnt lgkmcnt(5)
    v_mfma_f32_16x16x32_bf16 v[16:19], v[224:227], v[48:51], v[16:19]
    v_cvt_pk_bf16_f32 v10, v10, v14
    v_cvt_pk_bf16_f32 v11, v11, v15
    v_mfma_f32_16x16x32_bf16 v[20:23], v[228:231], v[48:51], v[20:23]
    ds_read_b128 v[44:47], v95 offset:3072
    ds_write_b128 v72, v[8:11] offset:8704
    v_mfma_f32_16x16x32_bf16 v[16:19], v[232:235], v[52:55], v[16:19]
    v_mfma_f32_16x16x32_bf16 v[20:23], v[236:239], v[52:55], v[20:23]
    ds_read_b128 v[48:51], v95 offset:4096
    s_waitcnt lgkmcnt(6)
    v_mfma_f32_16x16x32_bf16 v[16:19], v[240:243], v[56:59], v[16:19]
    v_mfma_f32_16x16x32_bf16 v[20:23], v[244:247], v[56:59], v[20:23]
    ds_read_b128 v[52:55], v95 offset:5120
    v_mfma_f32_16x16x32_bf16 v[16:19], v[248:251], v[60:63], v[16:19]
    v_mfma_f32_16x16x32_bf16 v[20:23], v[252:255], v[60:63], v[20:23]
    ds_read_b128 v[56:59], v95 offset:6144
    s_waitcnt lgkmcnt(6)
    v_mfma_f32_16x16x32_bf16 v[24:27], v[112:115], v[64:67], 0
    v_mfma_f32_16x16x32_bf16 v[28:31], v[116:119], v[64:67], 0
    ds_read_b128 v[60:63], v95 offset:7168
    v_mfma_f32_16x16x32_bf16 v[24:27], v[120:123], v[68:71], v[24:27]
    v_mfma_f32_16x16x32_bf16 v[28:31], v[124:127], v[68:71], v[28:31]
    ds_read_b128 v[64:67], v95 offset:8192
    s_waitcnt lgkmcnt(6)
    v_mfma_f32_16x16x32_bf16 v[24:27], v[128:131], v[40:43], v[24:27]
    v_mfma_f32_16x16x32_bf16 v[28:31], v[132:135], v[40:43], v[28:31]
    ds_read_b128 v[68:71], v95 offset:9216
    v_mfma_f32_16x16x32_bf16 v[24:27], v[136:139], v[44:47], v[24:27]
    ds_bpermute_b32 v74, v73, v18
    v_mfma_f32_16x16x32_bf16 v[28:31], v[140:143], v[44:47], v[28:31]
    ds_read_b128 v[40:43], v95 offset:10240
    s_waitcnt lgkmcnt(6)
    v_mfma_f32_16x16x32_bf16 v[24:27], v[144:147], v[48:51], v[24:27]
    v_mfma_f32_16x16x32_bf16 v[28:31], v[148:151], v[48:51], v[28:31]
    ds_read_b128 v[44:47], v95 offset:11264
    v_mfma_f32_16x16x32_bf16 v[24:27], v[152:155], v[52:55], v[24:27]
    s_waitcnt lgkmcnt(2)
    v_mul_f32 v74, 0xbae38e39, v74
    v_fma_f32 v16, v74, v104, v16
    v_mfma_f32_16x16x32_bf16 v[28:31], v[156:159], v[52:55], v[28:31]
    ds_read_b128 v[48:51], v95 offset:12288
    s_waitcnt lgkmcnt(6)
    v_mfma_f32_16x16x32_bf16 v[24:27], v[160:163], v[56:59], v[24:27]
    buffer_load_dwordx4 v[76:79], v88, s[40:43], s84 offen sc1
    buffer_load_dwordx4 v[80:83], v88, s[40:43], s84 offen offset:1024 sc1
    buffer_load_dword v84, v89, s[40:43], s84 offen offset:2048 sc1
    v_fma_f32 v17, v74, v105, v17
    v_mfma_f32_16x16x32_bf16 v[28:31], v[164:167], v[56:59], v[28:31]
    ds_read_b128 v[52:55], v95 offset:13312
    v_fma_f32 v18, v74, v106, v18
    v_mfma_f32_16x16x32_bf16 v[24:27], v[168:171], v[60:63], v[24:27]
    v_lshrrev_b32 v90, 4, v103
    v_mul_u32_u24 v90, 272, v90
    v_mfma_f32_16x16x32_bf16 v[28:31], v[172:175], v[60:63], v[28:31]
    ds_read_b128 v[56:59], v95 offset:14336
    s_waitcnt lgkmcnt(6)
    v_mfma_f32_16x16x32_bf16 v[24:27], v[176:179], v[64:67], v[24:27]
    v_and_b32 v85, 15, v103
    v_lshl_add_u32 v90, v85, 4, v90
    v_mfma_f32_16x16x32_bf16 v[28:31], v[180:183], v[64:67], v[28:31]
    ds_read_b128 v[60:63], v95 offset:15360
    v_fma_f32 v19, v74, v107, v19
    v_mfma_f32_16x16x32_bf16 v[24:27], v[184:187], v[68:71], v[24:27]
    v_add_u32 v90, 0x13880, v90
    v_fma_f32 v20, v74, v108, v20
    v_mfma_f32_16x16x32_bf16 v[28:31], v[188:191], v[68:71], v[28:31]
    v_add_u32 v98, 0, v97
    ds_read2_b64 v[64:67], v98 offset0:0 offset1:16
    s_waitcnt lgkmcnt(5)
    v_mfma_f32_16x16x32_bf16 v[24:27], v[192:195], v[40:43], v[24:27]
    v_fma_f32 v21, v74, v109, v21
    v_fma_f32 v22, v74, v110, v22
    v_mfma_f32_16x16x32_bf16 v[28:31], v[196:199], v[40:43], v[28:31]
    ds_read2_b64 v[68:71], v98 offset0:128 offset1:144
    v_fma_f32 v23, v74, v111, v23
    v_mfma_f32_16x16x32_bf16 v[24:27], v[200:203], v[44:47], v[24:27]
    v_cvt_pk_bf16_f32 v16, v16, v20
    v_cvt_pk_bf16_f32 v17, v17, v21
    v_mfma_f32_16x16x32_bf16 v[28:31], v[204:207], v[44:47], v[28:31]
    v_cvt_pk_bf16_f32 v18, v18, v22
    s_waitcnt lgkmcnt(4)
    v_mfma_f32_16x16x32_bf16 v[24:27], v[208:211], v[48:51], v[24:27]
    v_cvt_pk_bf16_f32 v19, v19, v23
    ds_write_b128 v72, v[16:19] offset:13056
    v_mfma_f32_16x16x32_bf16 v[28:31], v[212:215], v[48:51], v[28:31]
    v_mfma_f32_16x16x32_bf16 v[24:27], v[216:219], v[52:55], v[24:27]
    v_mfma_f32_16x16x32_bf16 v[28:31], v[220:223], v[52:55], v[28:31]
    s_waitcnt lgkmcnt(3)
    v_mfma_f32_16x16x32_bf16 v[24:27], v[224:227], v[56:59], v[24:27]
    v_mfma_f32_16x16x32_bf16 v[28:31], v[228:231], v[56:59], v[28:31]
    v_mfma_f32_16x16x32_bf16 v[24:27], v[232:235], v[60:63], v[24:27]
    v_mfma_f32_16x16x32_bf16 v[28:31], v[236:239], v[60:63], v[28:31]
    s_waitcnt lgkmcnt(1)
    v_mfma_f32_16x16x32_bf16 v[24:27], v[240:243], v[64:67], v[24:27]
    v_mfma_f32_16x16x32_bf16 v[28:31], v[244:247], v[64:67], v[28:31]
    v_mfma_f32_16x16x32_bf16 v[24:27], v[248:251], v[68:71], v[24:27]
    v_mfma_f32_16x16x32_bf16 v[28:31], v[252:255], v[68:71], v[28:31]
    s_mov_b32 s13, 0
    s_setprio 2
    s_add_u32 s66, s55, 1
    v_mov_b32 v99, s66
    ds_write_b32 v102, v99 offset:16
    s_nop 1
    ds_bpermute_b32 v74, v73, v26
    s_waitcnt lgkmcnt(0)
    v_mul_f32 v74, 0xbae38e39, v74
    v_fma_f32 v24, v74, v104, v24
    v_fma_f32 v25, v74, v105, v25
    v_fma_f32 v26, v74, v106, v26
    v_fma_f32 v27, v74, v107, v27
    v_fma_f32 v28, v74, v108, v28
    v_fma_f32 v29, v74, v109, v29
    v_fma_f32 v30, v74, v110, v30
    v_fma_f32 v31, v74, v111, v31
    v_cvt_pk_bf16_f32 v24, v24, v28
    v_cvt_pk_bf16_f32 v25, v25, v29
    v_cvt_pk_bf16_f32 v26, v26, v30
    v_cvt_pk_bf16_f32 v27, v27, v31
    ds_write_b128 v72, v[24:27] offset:4352
    s_waitcnt lgkmcnt(0)
    s_add_u32 s66, s55, 1
    v_mov_b32 v99, s66
    ds_write_b32 v102, v99 offset:32
    s_waitcnt vmcnt(0)
    v_max3_u32 v36, v76, v77, v78
    v_max3_u32 v36, v36, v79, v80
    v_max3_u32 v36, v36, v81, v82
    v_max3_u32 v36, v36, v83, v84
    v_cmp_eq_u32 vcc, -1, v36
    s_cmp_lg_u32 s55, 0
    s_cbranch_scc1 Lknf_68
    s_mov_b32 s67, 2
    s_nop 2
Lwf_69:
    ds_read_b128 v[40:43], v102 offset:128
    s_waitcnt lgkmcnt(0)
    v_min3_u32 v40, v40, v41, v42
    v_min_u32 v40, v40, v43
    s_nop 0
    v_readfirstlane_b32 s68, v40
    s_nop 1
    s_cmp_ge_u32 s68, s67
    s_nop 1
    s_cbranch_scc1 Lwfd_70
    s_sub_u32 s56, s56, 1
    s_cmp_eq_u32 s56, 0
    s_mov_b32 s69, 21
    s_cbranch_scc1 L_ABORT
    s_branch Lwf_69
Lwfd_70:
    v_and_b32 v44, 15, v103
    v_lshlrev_b32 v44, 4, v44
    v_add_u32 v45, 256, v44
    v_and_b32 v46, 16, v103
    s_cmp_eq_u32 s51, 0
    s_cselect_b32 s60, 0, 16
    v_and_b32 v46, s60, v46
    v_cmp_eq_u32 s[62:63], 0, v46
    s_nop 1
    v_cndmask_b32 v44, v44, v45, s[62:63]
    s_lshl_b32 s60, s51, 8
    s_add_u32 s60, s60, 21298944
    s_nop 0
Lini_71:
    buffer_load_dwordx4 v[40:43], v44, s[40:43], s60 offen sc1
    s_waitcnt vmcnt(0)
    v_xor_b32 v40, s58, v40
    v_xor_b32 v41, s59, v41
    v_xor_b32 v43, s58, v43
    v_or3_b32 v40, v40, v41, v43
    v_cmp_ne_u32 vcc, 0, v40
    s_nop 1
    s_cmp_eq_u64 vcc, 0
    s_nop 1
    s_cbranch_scc1 Linid_72
    s_sub_u32 s56, s56, 1
    s_cmp_eq_u32 s56, 0
    s_mov_b32 s69, 8
    s_cbranch_scc1 L_ABORT
    s_sleep 2
    s_branch Lini_71
Linid_72:
    v_cmp_ne_u32 vcc, s93, v42
    s_nop 1
    s_and_b64 vcc, vcc, s[62:63]
    s_cmp_eq_u64 vcc, 0
    s_cselect_b32 s85, 1, 0
    s_branch Lkrt_66
Lknf_68:
    s_and_b64 vcc, vcc, s[20:21]
    s_cbranch_scc0 Lkok_67
Lkrt_66:
    s_sub_u32 s56, s56, 1
    s_cmp_eq_u32 s56, 0
    s_mov_b32 s69, 5
    s_cbranch_scc1 L_ABORT
    buffer_load_dwordx4 v[76:79], v88, s[40:43], s84 offen sc1
    buffer_load_dwordx4 v[80:83], v88, s[40:43], s84 offen offset:1024 sc1
    buffer_load_dword v84, v89, s[40:43], s84 offen offset:2048 sc1
    s_waitcnt vmcnt(0)
    v_max3_u32 v36, v76, v77, v78
    v_max3_u32 v36, v36, v79, v80
    v_max3_u32 v36, v36, v81, v82
    v_max3_u32 v36, v36, v83, v84
    v_cmp_eq_u32 vcc, -1, v36
    s_nop 1
    s_and_b64 vcc, vcc, s[20:21]
    s_nop 1
    s_cbranch_scc1 Lkrt_66
Lkok_67:
    ds_write_b128 v90, v[76:79]
    ds_write_b128 v90, v[80:83] offset:1088
    ds_write_b32 v91, v84
    s_branch L_M_EPI
L_A_W1:
    v_add_u32 v98, 58368, v97
    ds_read_b128 v[40:43], v96 offset:19456
    ds_read_b128 v[44:47], v96 offset:20480
    ds_read_b128 v[48:51], v96 offset:21504
    ds_read_b128 v[52:55], v96 offset:22528
    ds_read_b128 v[56:59], v96 offset:23552
    ds_read_b128 v[60:63], v96 offset:24576
    ds_read_b128 v[64:67], v96 offset:25600
    s_waitcnt lgkmcnt(5)
    v_mfma_f32_16x16x32_bf16 v[0:3], v[112:115], v[40:43], 0
    v_and_b32 v74, 15, v103
    v_add_u32 v73, 48, v74
    v_mfma_f32_16x16x32_bf16 v[4:7], v[116:119], v[40:43], 0
    ds_read_b128 v[68:71], v96 offset:26624
    v_lshlrev_b32 v73, 2, v73
    v_mfma_f32_16x16x32_bf16 v[0:3], v[120:123], v[44:47], v[0:3]
    s_add_u32 s66, s57, 2
    v_mov_b32 v99, s66
    v_mfma_f32_16x16x32_bf16 v[4:7], v[124:127], v[44:47], v[4:7]
    ds_read_b128 v[40:43], v96 offset:27648
    s_waitcnt lgkmcnt(5)
    v_mfma_f32_16x16x32_bf16 v[0:3], v[128:131], v[48:51], v[0:3]
    s_cmp_eq_u32 s13, 0
    s_cbranch_scc1 Lop_73
    s_waitcnt vmcnt(10)
    ds_write_b32 v102, v99 offset:4
Lop_73:
    v_lshrrev_b32 v75, 4, v103
    v_mfma_f32_16x16x32_bf16 v[4:7], v[132:135], v[48:51], v[4:7]
    ds_read_b128 v[44:47], v96 offset:28672
    v_lshlrev_b32 v75, 3, v75
    v_mfma_f32_16x16x32_bf16 v[0:3], v[136:139], v[52:55], v[0:3]
    s_mov_b32 s65, 0x70403090
    v_bfe_u32 v72, s65, v75, 8
    v_mfma_f32_16x16x32_bf16 v[4:7], v[140:143], v[52:55], v[4:7]
    ds_read_b128 v[48:51], v96 offset:29696
    s_waitcnt lgkmcnt(5)
    v_mfma_f32_16x16x32_bf16 v[0:3], v[144:147], v[56:59], v[0:3]
    v_and_b32 v88, 7, v103
    v_lshl_add_u32 v88, v88, 8, v72
    v_mfma_f32_16x16x32_bf16 v[4:7], v[148:151], v[56:59], v[4:7]
    ds_read_b128 v[52:55], v96 offset:30720
    v_mul_u32_u24 v74, 272, v74
    v_mfma_f32_16x16x32_bf16 v[0:3], v[152:155], v[60:63], v[0:3]
    s_cmp_eq_u32 s7, 0
    s_cbranch_scc1 Lnopub_74
    s_mov_b32 s7, 0
    s_mov_b32 s54, 0
    s_cmp_eq_u32 s85, 0
    s_nop 3
    s_cbranch_scc1 Lslow_75
    s_lshl_b32 s60, s54, 9
    s_add_u32 s60, s60, s12
    s_lshl_b32 s61, s52, 3
    s_add_u32 s60, s60, s61
    s_add_u32 s61, s58, s53
    s_add_u32 s61, s61, 1
    v_mov_b32 v92, s61
    v_mov_b32 v93, s59
    v_mov_b32 v94, 0
    s_mov_b64 exec, 1
    s_waitcnt vmcnt(0)
    buffer_store_dwordx2 v[92:93], v94, s[40:43], s60 offen
    s_mov_b64 exec, -1
    s_branch Lmend_76
Lslow_75:
    s_lshl_b32 s60, s54, 9
    s_add_u32 s60, s60, s12
    s_lshl_b32 s61, s52, 3
    s_add_u32 s60, s60, s61
    s_add_u32 s61, s58, s53
    s_add_u32 s61, s61, 1
    v_mov_b32 v92, s61
    v_mov_b32 v93, s59
    v_mov_b32 v94, 0
    s_mov_b64 exec, 1
    s_waitcnt vmcnt(0)
    buffer_store_dwordx2 v[92:93], v94, s[40:43], s60 offen sc1
    s_mov_b64 exec, -1
Lmend_76:
    s_mov_b32 s54, 1
Lnopub_74:
    ds_read_b128 v[36:39], v102 offset:0
    v_mfma_f32_16x16x32_bf16 v[4:7], v[156:159], v[60:63], v[4:7]
    ds_read_b128 v[56:59], v96 offset:31744
    s_waitcnt lgkmcnt(6)
    v_mfma_f32_16x16x32_bf16 v[0:3], v[160:163], v[64:67], v[0:3]
    v_mfma_f32_16x16x32_bf16 v[4:7], v[164:167], v[64:67], v[4:7]
    ds_read_b128 v[60:63], v96 offset:32768
    v_mfma_f32_16x16x32_bf16 v[0:3], v[168:171], v[68:71], v[0:3]
    s_add_u32 s67, s57, 2
    s_waitcnt lgkmcnt(2)
    v_min3_u32 v36, v36, v37, v38
    v_mfma_f32_16x16x32_bf16 v[4:7], v[172:175], v[68:71], v[4:7]
    ds_read_b128 v[64:67], v96 offset:33792
    s_waitcnt lgkmcnt(6)
    v_mfma_f32_16x16x32_bf16 v[0:3], v[176:179], v[40:43], v[0:3]
    v_min_u32 v36, v36, v39
    v_mfma_f32_16x16x32_bf16 v[4:7], v[180:183], v[40:43], v[4:7]
    ds_read_b128 v[68:71], v96 offset:34816
    v_readfirstlane_b32 s68, v36
    v_mfma_f32_16x16x32_bf16 v[0:3], v[184:187], v[44:47], v[0:3]
    s_add_u32 s66, s57, 3
    v_add_u32 v74, 0x13000, v74
    v_mfma_f32_16x16x32_bf16 v[4:7], v[188:191], v[44:47], v[4:7]
    ds_read2_b64 v[40:43], v98 offset0:0 offset1:16
    s_waitcnt lgkmcnt(6)
    v_mfma_f32_16x16x32_bf16 v[0:3], v[192:195], v[48:51], v[0:3]
    v_mov_b32 v99, s66
    v_add_u32 v72, v72, v74
    s_cmp_ge_u32 s68, s67
    s_cbranch_scc1 Lck_77
    s_nop 4
Lwf_78:
    ds_read_b128 v[36:39], v102 offset:0
    s_waitcnt lgkmcnt(0)
    v_min3_u32 v36, v36, v37, v38
    v_min_u32 v36, v36, v39
    s_nop 0
    v_readfirstlane_b32 s68, v36
    s_nop 1
    s_cmp_ge_u32 s68, s67
    s_nop 1
    s_cbranch_scc1 Lwfd_79
    s_sub_u32 s56, s56, 1
    s_cmp_eq_u32 s56, 0
    s_mov_b32 s69, 2
    s_cbranch_scc1 L_ABORT
    s_branch Lwf_78
Lwfd_79:
Lck_77:
    s_cmp_eq_u32 s13, 0
    s_cbranch_scc1 Lop_80
    s_waitcnt vmcnt(5)
    ds_write_b32 v102, v99 offset:4
Lop_80:
    v_mfma_f32_16x16x32_bf16 v[4:7], v[196:199], v[48:51], v[4:7]
    ds_read2_b64 v[44:47], v98 offset0:128 offset1:144
    v_mfma_f32_16x16x32_bf16 v[0:3], v[200:203], v[52:55], v[0:3]
    ds_read_b128 v[36:39], v102 offset:48
    v_mfma_f32_16x16x32_bf16 v[4:7], v[204:207], v[52:55], v[4:7]
    ds_read_b128 v[48:51], v95 offset:19456
    s_waitcnt lgkmcnt(6)
    v_mfma_f32_16x16x32_bf16 v[0:3], v[208:211], v[56:59], v[0:3]
    v_mfma_f32_16x16x32_bf16 v[4:7], v[212:215], v[56:59], v[4:7]
    ds_read_b128 v[52:55], v95 offset:20480
    s_mov_b32 s67, s55
    v_mfma_f32_16x16x32_bf16 v[0:3], v[216:219], v[60:63], v[0:3]
    s_add_u32 s66, s57, 4
    s_waitcnt lgkmcnt(2)
    v_min3_u32 v36, v36, v37, v38
    v_mfma_f32_16x16x32_bf16 v[4:7], v[220:223], v[60:63], v[4:7]
    ds_read_b128 v[56:59], v95 offset:21504
    s_waitcnt lgkmcnt(6)
    v_mfma_f32_16x16x32_bf16 v[0:3], v[224:227], v[64:67], v[0:3]
    v_mov_b32 v99, s66
    v_min_u32 v36, v36, v39
    v_mfma_f32_16x16x32_bf16 v[4:7], v[228:231], v[64:67], v[4:7]
    ds_read_b128 v[60:63], v95 offset:22528
    s_cmp_eq_u32 s13, 0
    s_cbranch_scc1 Lop_81
    s_waitcnt vmcnt(0)
    ds_write_b32 v102, v99 offset:4
Lop_81:
    v_mfma_f32_16x16x32_bf16 v[0:3], v[232:235], v[68:71], v[0:3]
    v_readfirstlane_b32 s68, v36
    v_mfma_f32_16x16x32_bf16 v[4:7], v[236:239], v[68:71], v[4:7]
    ds_read_b128 v[64:67], v95 offset:23552
    s_waitcnt lgkmcnt(6)
    v_mfma_f32_16x16x32_bf16 v[0:3], v[240:243], v[40:43], v[0:3]
    s_cmp_ge_u32 s68, s67
    s_cbranch_scc1 Lck_82
    s_nop 6
Lwf_83:
    ds_read_b128 v[36:39], v102 offset:48
    s_waitcnt lgkmcnt(0)
    v_min3_u32 v36, v36, v37, v38
    v_min_u32 v36, v36, v39
    s_nop 0
    v_readfirstlane_b32 s68, v36
    s_nop 1
    s_cmp_ge_u32 s68, s67
    s_nop 1
    s_cbranch_scc1 Lwfd_84
    s_sub_u32 s56, s56, 1
    s_cmp_eq_u32 s56, 0
    s_mov_b32 s69, 3
    s_cbranch_scc1 L_ABORT
    s_branch Lwf_83
Lwfd_84:
Lck_82:
    v_mfma_f32_16x16x32_bf16 v[4:7], v[244:247], v[40:43], v[4:7]
    ds_read_b128 v[68:71], v95 offset:24576
    v_mfma_f32_16x16x32_bf16 v[0:3], v[248:251], v[44:47], v[0:3]
    v_mfma_f32_16x16x32_bf16 v[4:7], v[252:255], v[44:47], v[4:7]
    ds_read_b128 v[40:43], v95 offset:25600
    s_waitcnt lgkmcnt(5)
    v_mfma_f32_16x16x32_bf16 v[8:11], v[112:115], v[48:51], 0
    v_mfma_f32_16x16x32_bf16 v[12:15], v[116:119], v[48:51], 0
    ds_read_b128 v[44:47], v95 offset:26624
    v_mfma_f32_16x16x32_bf16 v[8:11], v[120:123], v[52:55], v[8:11]
    v_mfma_f32_16x16x32_bf16 v[12:15], v[124:127], v[52:55], v[12:15]
    ds_read_b128 v[48:51], v95 offset:27648
    s_waitcnt lgkmcnt(5)
    v_mfma_f32_16x16x32_bf16 v[8:11], v[128:131], v[56:59], v[8:11]
    v_mfma_f32_16x16x32_bf16 v[12:15], v[132:135], v[56:59], v[12:15]
    ds_read_b128 v[52:55], v95 offset:28672
    v_mfma_f32_16x16x32_bf16 v[8:11], v[136:139], v[60:63], v[8:11]
    ds_bpermute_b32 v74, v73, v2
    v_mfma_f32_16x16x32_bf16 v[12:15], v[140:143], v[60:63], v[12:15]
    ds_read_b128 v[56:59], v95 offset:29696
    s_waitcnt lgkmcnt(6)
    v_mfma_f32_16x16x32_bf16 v[8:11], v[144:147], v[64:67], v[8:11]
    v_mfma_f32_16x16x32_bf16 v[12:15], v[148:151], v[64:67], v[12:15]
    ds_read_b128 v[60:63], v95 offset:30720
    s_waitcnt lgkmcnt(2)
    v_mul_f32 v74, 0xbae38e39, v74
    v_mfma_f32_16x16x32_bf16 v[8:11], v[152:155], v[68:71], v[8:11]
    v_fma_f32 v0, v74, v104, v0
    v_fma_f32 v1, v74, v105, v1
    v_mfma_f32_16x16x32_bf16 v[12:15], v[156:159], v[68:71], v[12:15]
    ds_read_b128 v[64:67], v95 offset:31744
    s_waitcnt lgkmcnt(6)
    v_mfma_f32_16x16x32_bf16 v[8:11], v[160:163], v[40:43], v[8:11]
    v_fma_f32 v2, v74, v106, v2
    v_fma_f32 v3, v74, v107, v3
    v_fma_f32 v4, v74, v108, v4
    v_mfma_f32_16x16x32_bf16 v[12:15], v[164:167], v[40:43], v[12:15]
    ds_read_b128 v[68:71], v95 offset:32768
    v_fma_f32 v5, v74, v109, v5
    v_mfma_f32_16x16x32_bf16 v[8:11], v[168:171], v[44:47], v[8:11]
    ds_read_b128 v[36:39], v102 offset:0
    v_fma_f32 v6, v74, v110, v6
    v_fma_f32 v7, v74, v111, v7
    v_mfma_f32_16x16x32_bf16 v[12:15], v[172:175], v[44:47], v[12:15]
    ds_read_b128 v[40:43], v95 offset:33792
    s_waitcnt lgkmcnt(7)
    v_mfma_f32_16x16x32_bf16 v[8:11], v[176:179], v[48:51], v[8:11]
    v_cvt_pk_bf16_f32 v0, v0, v4
    v_cvt_pk_bf16_f32 v1, v1, v5
    s_add_u32 s67, s57, 3
    v_cvt_pk_bf16_f32 v2, v2, v6
    v_mfma_f32_16x16x32_bf16 v[12:15], v[180:183], v[48:51], v[12:15]
    ds_read_b128 v[44:47], v95 offset:34816
    s_waitcnt lgkmcnt(2)
    v_min3_u32 v36, v36, v37, v38
    v_mfma_f32_16x16x32_bf16 v[8:11], v[184:187], v[52:55], v[8:11]
    v_cvt_pk_bf16_f32 v3, v3, v7
    v_min_u32 v36, v36, v39
    s_mov_b32 exec_lo, 0xff00ff00
    s_mov_b32 exec_hi, 0xff00ff00
    buffer_store_dwordx4 v[0:3], v88, s[40:43], s83 offen sc1
    s_mov_b64 exec, -1
    ds_write_b128 v72, v[0:3] offset:17408
    v_mfma_f32_16x16x32_bf16 v[12:15], v[188:191], v[52:55], v[12:15]
    v_add_u32 v98, 19456, v97
    ds_read2_b64 v[48:51], v98 offset0:0 offset1:16
    s_waitcnt lgkmcnt(7)
    v_mfma_f32_16x16x32_bf16 v[8:11], v[192:195], v[56:59], v[8:11]
    v_readfirstlane_b32 s68, v36
    s_cmp_ge_u32 s68, s67
    s_cbranch_scc1 Lck_85
    s_nop 5
Lwf_86:
    ds_read_b128 v[36:39], v102 offset:0
    s_waitcnt lgkmcnt(0)
    v_min3_u32 v36, v36, v37, v38
    v_min_u32 v36, v36, v39
    s_nop 0
    v_readfirstlane_b32 s68, v36
    s_nop 1
    s_cmp_ge_u32 s68, s67
    s_nop 1
    s_cbranch_scc1 Lwfd_87
    s_sub_u32 s56, s56, 1
    s_cmp_eq_u32 s56, 0
    s_mov_b32 s69, 2
    s_cbranch_scc1 L_ABORT
    s_branch Lwf_86
Lwfd_87:
Lck_85:
    v_mfma_f32_16x16x32_bf16 v[12:15], v[196:199], v[56:59], v[12:15]
    ds_read2_b64 v[52:55], v98 offset0:128 offset1:144
    v_lshrrev_b32 v32, 4, v103
    v_mfma_f32_16x16x32_bf16 v[8:11], v[200:203], v[60:63], v[8:11]
    v_lshl_add_u32 v32, v32, 8, v73
    v_add_u32 v32, 0x9340, v32
    v_mfma_f32_16x16x32_bf16 v[12:15], v[204:207], v[60:63], v[12:15]
    ds_read_b128 v[56:59], v96 offset:0
    s_waitcnt lgkmcnt(7)
    v_mfma_f32_16x16x32_bf16 v[8:11], v[208:211], v[64:67], v[8:11]
    ds_read2_b32 v[34:35], v32 offset0:32 offset1:48
    ds_read2_b32 v[32:33], v32 offset0:0 offset1:16
    v_mfma_f32_16x16x32_bf16 v[12:15], v[212:215], v[64:67], v[12:15]
    ds_read_b128 v[60:63], v96 offset:1024
    v_mfma_f32_16x16x32_bf16 v[8:11], v[216:219], v[68:71], v[8:11]
    v_mfma_f32_16x16x32_bf16 v[12:15], v[220:223], v[68:71], v[12:15]
    ds_read_b128 v[64:67], v96 offset:2048
    s_waitcnt lgkmcnt(8)
    v_mfma_f32_16x16x32_bf16 v[8:11], v[224:227], v[40:43], v[8:11]
    s_waitcnt lgkmcnt(2)
    v_add_f32 v32, v32, v33
    v_add_f32 v34, v34, v35
    v_mfma_f32_16x16x32_bf16 v[12:15], v[228:231], v[40:43], v[12:15]
    ds_read_b128 v[68:71], v96 offset:3072
    v_add_f32 v32, v32, v34
    v_mfma_f32_16x16x32_bf16 v[8:11], v[232:235], v[44:47], v[8:11]
    v_mov_b32 v33, v32
    s_nop 1
    v_permlane32_swap_b32 v32, v33
    v_mfma_f32_16x16x32_bf16 v[12:15], v[236:239], v[44:47], v[12:15]
    ds_read_b128 v[40:43], v96 offset:4096
    s_waitcnt lgkmcnt(7)
    v_mfma_f32_16x16x32_bf16 v[8:11], v[240:243], v[48:51], v[8:11]
    v_add_f32 v32, v32, v33
    v_mov_b32 v33, v32
    v_mfma_f32_16x16x32_bf16 v[12:15], v[244:247], v[48:51], v[12:15]
    ds_read_b128 v[44:47], v96 offset:5120
    v_permlane16_swap_b32 v32, v33
    v_mfma_f32_16x16x32_bf16 v[8:11], v[248:251], v[52:55], v[8:11]
    v_add_f32 v32, v32, v33
    v_mul_f32 v32, 0x3ae38e39, v32
    v_mfma_f32_16x16x32_bf16 v[12:15], v[252:255], v[52:55], v[12:15]
    ds_read_b128 v[48:51], v96 offset:6144
    s_waitcnt lgkmcnt(5)
    v_mfma_f32_16x16x32_bf16 v[16:19], v[112:115], v[56:59], 0
    v_mfma_f32_16x16x32_bf16 v[20:23], v[116:119], v[56:59], 0
    ds_read_b128 v[52:55], v96 offset:7168
    v_mfma_f32_16x16x32_bf16 v[16:19], v[120:123], v[60:63], v[16:19]
    v_mfma_f32_16x16x32_bf16 v[20:23], v[124:127], v[60:63], v[20:23]
    ds_read_b128 v[56:59], v96 offset:8192
    s_waitcnt lgkmcnt(5)
    v_mfma_f32_16x16x32_bf16 v[16:19], v[128:131], v[64:67], v[16:19]
    v_mfma_f32_16x16x32_bf16 v[20:23], v[132:135], v[64:67], v[20:23]
    ds_read_b128 v[60:63], v96 offset:9216
    v_mfma_f32_16x16x32_bf16 v[16:19], v[136:139], v[68:71], v[16:19]
    ds_read_b128 v[36:39], v102 offset:0
    v_mfma_f32_16x16x32_bf16 v[20:23], v[140:143], v[68:71], v[20:23]
    ds_read_b128 v[64:67], v96 offset:10240
    s_waitcnt lgkmcnt(6)
    v_mfma_f32_16x16x32_bf16 v[16:19], v[144:147], v[40:43], v[16:19]
    v_mfma_f32_16x16x32_bf16 v[20:23], v[148:151], v[40:43], v[20:23]
    ds_read_b128 v[68:71], v96 offset:11264
    s_add_u32 s67, s57, 4
    v_mfma_f32_16x16x32_bf16 v[16:19], v[152:155], v[44:47], v[16:19]
    s_waitcnt lgkmcnt(2)
    v_min3_u32 v36, v36, v37, v38
    v_min_u32 v36, v36, v39
    v_mfma_f32_16x16x32_bf16 v[20:23], v[156:159], v[44:47], v[20:23]
    ds_read_b128 v[40:43], v96 offset:12288
    s_waitcnt lgkmcnt(6)
    v_mfma_f32_16x16x32_bf16 v[16:19], v[160:163], v[48:51], v[16:19]
    v_readfirstlane_b32 s68, v36
    v_mfma_f32_16x16x32_bf16 v[20:23], v[164:167], v[48:51], v[20:23]
    ds_read_b128 v[44:47], v96 offset:13312
    v_mfma_f32_16x16x32_bf16 v[16:19], v[168:171], v[52:55], v[16:19]
    s_cmp_ge_u32 s68, s67
    s_cbranch_scc1 Lck_88
    s_nop 6
Lwf_89:
    ds_read_b128 v[36:39], v102 offset:0
    s_waitcnt lgkmcnt(0)
    v_min3_u32 v36, v36, v37, v38
    v_min_u32 v36, v36, v39
    s_nop 0
    v_readfirstlane_b32 s68, v36
    s_nop 1
    s_cmp_ge_u32 s68, s67
    s_nop 1
    s_cbranch_scc1 Lwfd_90
    s_sub_u32 s56, s56, 1
    s_cmp_eq_u32 s56, 0
    s_mov_b32 s69, 2
    s_cbranch_scc1 L_ABORT
    s_branch Lwf_89
Lwfd_90:
Lck_88:
    ds_bpermute_b32 v74, v73, v10
    v_mfma_f32_16x16x32_bf16 v[20:23], v[172:175], v[52:55], v[20:23]
    ds_read_b128 v[48:51], v96 offset:14336
    s_waitcnt lgkmcnt(7)
    v_mfma_f32_16x16x32_bf16 v[16:19], v[176:179], v[56:59], v[16:19]
    v_mfma_f32_16x16x32_bf16 v[20:23], v[180:183], v[56:59], v[20:23]
    ds_read_b128 v[52:55], v96 offset:15360
    v_mfma_f32_16x16x32_bf16 v[16:19], v[184:187], v[60:63], v[16:19]
    v_add_u32 v34, 0x226c0, v73
    v_mfma_f32_16x16x32_bf16 v[20:23], v[188:191], v[60:63], v[20:23]
    v_add_u32 v98, 38912, v97
    ds_read2_b64 v[56:59], v98 offset0:0 offset1:16
    s_waitcnt lgkmcnt(6)
    v_mfma_f32_16x16x32_bf16 v[16:19], v[192:195], v[64:67], v[16:19]
    s_waitcnt lgkmcnt(3)
    v_mul_f32 v74, 0xbae38e39, v74
    v_fma_f32 v8, v74, v104, v8
    v_mfma_f32_16x16x32_bf16 v[20:23], v[196:199], v[64:67], v[20:23]
    ds_read2_b64 v[60:63], v98 offset0:128 offset1:144
    v_fma_f32 v9, v74, v105, v9
    v_mfma_f32_16x16x32_bf16 v[16:19], v[200:203], v[68:71], v[16:19]
    v_fma_f32 v10, v74, v106, v10
    v_fma_f32 v11, v74, v107, v11
    v_mfma_f32_16x16x32_bf16 v[20:23], v[204:207], v[68:71], v[20:23]
    ds_read_b128 v[64:67], v95 offset:0
    s_waitcnt lgkmcnt(6)
    v_mfma_f32_16x16x32_bf16 v[16:19], v[208:211], v[40:43], v[16:19]
    v_fma_f32 v12, v74, v108, v12
    v_fma_f32 v13, v74, v109, v13
    v_mfma_f32_16x16x32_bf16 v[20:23], v[212:215], v[40:43], v[20:23]
    ds_read_b128 v[68:71], v95 offset:1024
    v_fma_f32 v14, v74, v110, v14
    v_mfma_f32_16x16x32_bf16 v[16:19], v[216:219], v[44:47], v[16:19]
    v_fma_f32 v15, v74, v111, v15
    v_cvt_pk_bf16_f32 v8, v8, v12
    v_mfma_f32_16x16x32_bf16 v[20:23], v[220:223], v[44:47], v[20:23]
    ds_read_b128 v[40:43], v95 offset:2048
    s_waitcnt lgkmcnt(5)
    v_mfma_f32_16x16x32_bf16 v[16:19], v[224:227], v[48:51], v[16:19]
    v_cvt_pk_bf16_f32 v9, v9, v13
    v_cvt_pk_bf16_f32 v10, v10, v14
    v_mfma_f32_16x16x32_bf16 v[20:23], v[228:231], v[48:51], v[20:23]
    ds_read_b128 v[44:47], v95 offset:3072
    v_cvt_pk_bf16_f32 v11, v11, v15
    v_mfma_f32_16x16x32_bf16 v[16:19], v[232:235], v[52:55], v[16:19]
    ds_write_b128 v72, v[8:11] offset:8704
    v_fma_f32 v32, -v74, v74, v32
    v_mfma_f32_16x16x32_bf16 v[20:23], v[236:239], v[52:55], v[20:23]
    ds_read_b128 v[48:51], v95 offset:4096
    s_waitcnt lgkmcnt(6)
    v_mfma_f32_16x16x32_bf16 v[16:19], v[240:243], v[56:59], v[16:19]
    v_max_f32 v32, 0, v32
    v_add_f32 v32, 0x3727c5ac, v32
    v_mfma_f32_16x16x32_bf16 v[20:23], v[244:247], v[56:59], v[20:23]
    ds_read_b128 v[52:55], v95 offset:5120
    v_rsq_f32 v32, v32
    v_mfma_f32_16x16x32_bf16 v[16:19], v[248:251], v[60:63], v[16:19]
    s_mov_b64 exec, 0xffff
    ds_write_b32 v34, v32
    s_mov_b64 exec, -1
    v_mfma_f32_16x16x32_bf16 v[20:23], v[252:255], v[60:63], v[20:23]
    ds_read_b128 v[56:59], v95 offset:6144
    s_waitcnt lgkmcnt(7)
    v_mfma_f32_16x16x32_bf16 v[24:27], v[112:115], v[64:67], 0
    v_mfma_f32_16x16x32_bf16 v[28:31], v[116:119], v[64:67], 0
    ds_read_b128 v[60:63], v95 offset:7168
    v_mfma_f32_16x16x32_bf16 v[24:27], v[120:123], v[68:71], v[24:27]
    v_mfma_f32_16x16x32_bf16 v[28:31], v[124:127], v[68:71], v[28:31]
    ds_read_b128 v[64:67], v95 offset:8192
    s_waitcnt lgkmcnt(7)
    v_mfma_f32_16x16x32_bf16 v[24:27], v[128:131], v[40:43], v[24:27]
    v_mfma_f32_16x16x32_bf16 v[28:31], v[132:135], v[40:43], v[28:31]
    ds_read_b128 v[68:71], v95 offset:9216
    v_mfma_f32_16x16x32_bf16 v[24:27], v[136:139], v[44:47], v[24:27]
    ds_bpermute_b32 v74, v73, v18
    v_mfma_f32_16x16x32_bf16 v[28:31], v[140:143], v[44:47], v[28:31]
    ds_read_b128 v[40:43], v95 offset:10240
    s_waitcnt lgkmcnt(7)
    v_mfma_f32_16x16x32_bf16 v[24:27], v[144:147], v[48:51], v[24:27]
    v_mfma_f32_16x16x32_bf16 v[28:31], v[148:151], v[48:51], v[28:31]
    ds_read_b128 v[44:47], v95 offset:11264
    v_mfma_f32_16x16x32_bf16 v[24:27], v[152:155], v[52:55], v[24:27]
    s_waitcnt lgkmcnt(2)
    v_mul_f32 v74, 0xbae38e39, v74
    v_fma_f32 v16, v74, v104, v16
    v_mfma_f32_16x16x32_bf16 v[28:31], v[156:159], v[52:55], v[28:31]
    ds_read_b128 v[48:51], v95 offset:12288
    s_waitcnt lgkmcnt(6)
    v_mfma_f32_16x16x32_bf16 v[24:27], v[160:163], v[56:59], v[24:27]
    v_fma_f32 v17, v74, v105, v17
    v_fma_f32 v18, v74, v106, v18
    v_mfma_f32_16x16x32_bf16 v[28:31], v[164:167], v[56:59], v[28:31]
    ds_read_b128 v[52:55], v95 offset:13312
    v_fma_f32 v19, v74, v107, v19
    v_mfma_f32_16x16x32_bf16 v[24:27], v[168:171], v[60:63], v[24:27]
    v_fma_f32 v20, v74, v108, v20
    v_fma_f32 v21, v74, v109, v21
    v_mfma_f32_16x16x32_bf16 v[28:31], v[172:175], v[60:63], v[28:31]
    ds_read_b128 v[56:59], v95 offset:14336
    s_waitcnt lgkmcnt(6)
    v_mfma_f32_16x16x32_bf16 v[24:27], v[176:179], v[64:67], v[24:27]
    v_fma_f32 v22, v74, v110, v22
    v_fma_f32 v23, v74, v111, v23
    v_mfma_f32_16x16x32_bf16 v[28:31], v[180:183], v[64:67], v[28:31]
    ds_read_b128 v[60:63], v95 offset:15360
    v_cvt_pk_bf16_f32 v16, v16, v20
    v_mfma_f32_16x16x32_bf16 v[24:27], v[184:187], v[68:71], v[24:27]
    v_cvt_pk_bf16_f32 v17, v17, v21
    v_cvt_pk_bf16_f32 v18, v18, v22
    v_mfma_f32_16x16x32_bf16 v[28:31], v[188:191], v[68:71], v[28:31]
    v_add_u32 v98, 0, v97
    ds_read2_b64 v[64:67], v98 offset0:0 offset1:16
    s_waitcnt lgkmcnt(5)
    v_mfma_f32_16x16x32_bf16 v[24:27], v[192:195], v[40:43], v[24:27]
    v_cvt_pk_bf16_f32 v19, v19, v23
    ds_write_b128 v72, v[16:19] offset:13056
    v_mfma_f32_16x16x32_bf16 v[28:31], v[196:199], v[40:43], v[28:31]
    ds_read2_b64 v[68:71], v98 offset0:128 offset1:144
    v_mfma_f32_16x16x32_bf16 v[24:27], v[200:203], v[44:47], v[24:27]
    v_mfma_f32_16x16x32_bf16 v[28:31], v[204:207], v[44:47], v[28:31]
    s_waitcnt lgkmcnt(5)
    v_mfma_f32_16x16x32_bf16 v[24:27], v[208:211], v[48:51], v[24:27]
    v_mfma_f32_16x16x32_bf16 v[28:31], v[212:215], v[48:51], v[28:31]
    v_mfma_f32_16x16x32_bf16 v[24:27], v[216:219], v[52:55], v[24:27]
    v_mfma_f32_16x16x32_bf16 v[28:31], v[220:223], v[52:55], v[28:31]
    s_waitcnt lgkmcnt(3)
    v_mfma_f32_16x16x32_bf16 v[24:27], v[224:227], v[56:59], v[24:27]
    v_mfma_f32_16x16x32_bf16 v[28:31], v[228:231], v[56:59], v[28:31]
    v_mfma_f32_16x16x32_bf16 v[24:27], v[232:235], v[60:63], v[24:27]
    v_mfma_f32_16x16x32_bf16 v[28:31], v[236:239], v[60:63], v[28:31]
    s_waitcnt lgkmcnt(0)
    v_mfma_f32_16x16x32_bf16 v[24:27], v[240:243], v[64:67], v[24:27]
    v_mfma_f32_16x16x32_bf16 v[28:31], v[244:247], v[64:67], v[28:31]
    v_mfma_f32_16x16x32_bf16 v[24:27], v[248:251], v[68:71], v[24:27]
    v_mfma_f32_16x16x32_bf16 v[28:31], v[252:255], v[68:71], v[28:31]
    s_mov_b32 s13, 0
    s_setprio 2
    s_add_u32 s66, s55, 1
    v_mov_b32 v99, s66
    ds_write_b32 v102, v99 offset:20
    s_nop 1
    ds_bpermute_b32 v74, v73, v26
    s_waitcnt lgkmcnt(0)
    v_mul_f32 v74, 0xbae38e39, v74
    v_fma_f32 v24, v74, v104, v24
    v_fma_f32 v25, v74, v105, v25
    v_fma_f32 v26, v74, v106, v26
    v_fma_f32 v27, v74, v107, v27
    v_fma_f32 v28, v74, v108, v28
    v_fma_f32 v29, v74, v109, v29
    v_fma_f32 v30, v74, v110, v30
    v_fma_f32 v31, v74, v111, v31
    v_cvt_pk_bf16_f32 v24, v24, v28
    v_cvt_pk_bf16_f32 v25, v25, v29
    v_cvt_pk_bf16_f32 v26, v26, v30
    v_cvt_pk_bf16_f32 v27, v27, v31
    ds_write_b128 v72, v[24:27] offset:4352
    s_waitcnt lgkmcnt(0)
    s_add_u32 s66, s55, 1
    v_mov_b32 v99, s66
    ds_write_b32 v102, v99 offset:36
    s_cmp_lg_u32 s55, 0
    s_nop 0
    s_cbranch_scc1 Lknf_91
    s_mov_b32 s67, 2
Lwf_92:
    ds_read_b128 v[40:43], v102 offset:128
    s_waitcnt lgkmcnt(0)
    v_min3_u32 v40, v40, v41, v42
    v_min_u32 v40, v40, v43
    s_nop 0
    v_readfirstlane_b32 s68, v40
    s_nop 1
    s_cmp_ge_u32 s68, s67
    s_nop 1
    s_cbranch_scc1 Lwfd_93
    s_sub_u32 s56, s56, 1
    s_cmp_eq_u32 s56, 0
    s_mov_b32 s69, 21
    s_cbranch_scc1 L_ABORT
    s_branch Lwf_92
Lwfd_93:
    v_and_b32 v44, 15, v103
    v_lshlrev_b32 v44, 4, v44
    v_add_u32 v45, 256, v44
    v_and_b32 v46, 16, v103
    s_cmp_eq_u32 s51, 0
    s_cselect_b32 s60, 0, 16
    v_and_b32 v46, s60, v46
    v_cmp_eq_u32 s[62:63], 0, v46
    s_nop 1
    v_cndmask_b32 v44, v44, v45, s[62:63]
    s_lshl_b32 s60, s51, 8
    s_add_u32 s60, s60, 21298944
    s_nop 0
Lini_94:
    buffer_load_dwordx4 v[40:43], v44, s[40:43], s60 offen sc1
    s_waitcnt vmcnt(0)
    v_xor_b32 v40, s58, v40
    v_xor_b32 v41, s59, v41
    v_xor_b32 v43, s58, v43
    v_or3_b32 v40, v40, v41, v43
    v_cmp_ne_u32 vcc, 0, v40
    s_nop 1
    s_cmp_eq_u64 vcc, 0
    s_nop 1
    s_cbranch_scc1 Linid_95
    s_sub_u32 s56, s56, 1
    s_cmp_eq_u32 s56, 0
    s_mov_b32 s69, 8
    s_cbranch_scc1 L_ABORT
    s_sleep 2
    s_branch Lini_94
Linid_95:
    v_cmp_ne_u32 vcc, s93, v42
    s_nop 1
    s_and_b64 vcc, vcc, s[62:63]
    s_cmp_eq_u64 vcc, 0
    s_cselect_b32 s85, 1, 0
Lknf_91:
    s_branch L_M_EPI
L_A_W2:
    v_add_u32 v98, 58368, v97
    ds_read_b128 v[40:43], v96 offset:19456
    ds_read_b128 v[44:47], v96 offset:20480
    ds_read_b128 v[48:51], v96 offset:21504
    ds_read_b128 v[52:55], v96 offset:22528
    ds_read_b128 v[56:59], v96 offset:23552
    ds_read_b128 v[60:63], v96 offset:24576
    ds_read_b128 v[64:67], v96 offset:25600
    s_waitcnt lgkmcnt(5)
    v_mfma_f32_16x16x32_bf16 v[0:3], v[112:115], v[40:43], 0
    v_and_b32 v74, 15, v103
    v_add_u32 v73, 48, v74
    v_mfma_f32_16x16x32_bf16 v[4:7], v[116:119], v[40:43], 0
    ds_read_b128 v[68:71], v96 offset:26624
    v_lshlrev_b32 v73, 2, v73
    v_mfma_f32_16x16x32_bf16 v[0:3], v[120:123], v[44:47], v[0:3]
    s_add_u32 s66, s57, 2
    v_mov_b32 v99, s66
    v_mfma_f32_16x16x32_bf16 v[4:7], v[124:127], v[44:47], v[4:7]
    ds_read_b128 v[40:43], v96 offset:27648
    s_waitcnt lgkmcnt(5)
    v_mfma_f32_16x16x32_bf16 v[0:3], v[128:131], v[48:51], v[0:3]
    s_cmp_eq_u32 s13, 0
    s_cbranch_scc1 Lop_96
    s_waitcnt vmcnt(10)
    ds_write_b32 v102, v99 offset:8
Lop_96:
    v_lshrrev_b32 v75, 4, v103
    v_mfma_f32_16x16x32_bf16 v[4:7], v[132:135], v[48:51], v[4:7]
    ds_read_b128 v[44:47], v96 offset:28672
    v_lshlrev_b32 v75, 3, v75
    v_mfma_f32_16x16x32_bf16 v[0:3], v[136:139], v[52:55], v[0:3]
    s_mov_b32 s65, 0xd020c0b0
    v_bfe_u32 v72, s65, v75, 8
    v_mfma_f32_16x16x32_bf16 v[4:7], v[140:143], v[52:55], v[4:7]
    ds_read_b128 v[48:51], v96 offset:29696
    s_waitcnt lgkmcnt(5)
    v_mfma_f32_16x16x32_bf16 v[0:3], v[144:147], v[56:59], v[0:3]
    v_and_b32 v88, 7, v103
    v_lshl_add_u32 v88, v88, 8, v72
    v_mfma_f32_16x16x32_bf16 v[4:7], v[148:151], v[56:59], v[4:7]
    ds_read_b128 v[52:55], v96 offset:30720
    v_mul_u32_u24 v74, 272, v74
    v_mfma_f32_16x16x32_bf16 v[0:3], v[152:155], v[60:63], v[0:3]
    s_cmp_eq_u32 s7, 0
    s_cbranch_scc1 Lnopub_97
    s_mov_b32 s7, 0
    s_mov_b32 s54, 0
    s_cmp_eq_u32 s85, 0
    s_nop 3
    s_cbranch_scc1 Lslow_98
    s_lshl_b32 s60, s54, 9
    s_add_u32 s60, s60, s12
    s_lshl_b32 s61, s52, 3
    s_add_u32 s60, s60, s61
    s_add_u32 s61, s58, s53
    s_add_u32 s61, s61, 1
    v_mov_b32 v92, s61
    v_mov_b32 v93, s59
    v_mov_b32 v94, 0
    s_mov_b64 exec, 1
    s_waitcnt vmcnt(0)
    buffer_store_dwordx2 v[92:93], v94, s[40:43], s60 offen
    s_mov_b64 exec, -1
    s_branch Lmend_99
Lslow_98:
    s_lshl_b32 s60, s54, 9
    s_add_u32 s60, s60, s12
    s_lshl_b32 s61, s52, 3
    s_add_u32 s60, s60, s61
    s_add_u32 s61, s58, s53
    s_add_u32 s61, s61, 1
    v_mov_b32 v92, s61
    v_mov_b32 v93, s59
    v_mov_b32 v94, 0
    s_mov_b64 exec, 1
    s_waitcnt vmcnt(0)
    buffer_store_dwordx2 v[92:93], v94, s[40:43], s60 offen sc1
    s_mov_b64 exec, -1
Lmend_99:
    s_mov_b32 s54, 1
Lnopub_97:
    ds_read_b128 v[36:39], v102 offset:0
    v_mfma_f32_16x16x32_bf16 v[4:7], v[156:159], v[60:63], v[4:7]
    ds_read_b128 v[56:59], v96 offset:31744
    s_waitcnt lgkmcnt(6)
    v_mfma_f32_16x16x32_bf16 v[0:3], v[160:163], v[64:67], v[0:3]
    v_mfma_f32_16x16x32_bf16 v[4:7], v[164:167], v[64:67], v[4:7]
    ds_read_b128 v[60:63], v96 offset:32768
    v_mfma_f32_16x16x32_bf16 v[0:3], v[168:171], v[68:71], v[0:3]
    s_add_u32 s67, s57, 2
    s_waitcnt lgkmcnt(2)
    v_min3_u32 v36, v36, v37, v38
    v_mfma_f32_16x16x32_bf16 v[4:7], v[172:175], v[68:71], v[4:7]
    ds_read_b128 v[64:67], v96 offset:33792
    s_waitcnt lgkmcnt(6)
    v_mfma_f32_16x16x32_bf16 v[0:3], v[176:179], v[40:43], v[0:3]
    v_min_u32 v36, v36, v39
    v_mfma_f32_16x16x32_bf16 v[4:7], v[180:183], v[40:43], v[4:7]
    ds_read_b128 v[68:71], v96 offset:34816
    v_readfirstlane_b32 s68, v36
    v_mfma_f32_16x16x32_bf16 v[0:3], v[184:187], v[44:47], v[0:3]
    s_add_u32 s66, s57, 3
    v_add_u32 v74, 0x13000, v74
    v_mfma_f32_16x16x32_bf16 v[4:7], v[188:191], v[44:47], v[4:7]
    ds_read2_b64 v[40:43], v98 offset0:0 offset1:16
    s_waitcnt lgkmcnt(6)
    v_mfma_f32_16x16x32_bf16 v[0:3], v[192:195], v[48:51], v[0:3]
    v_mov_b32 v99, s66
    v_add_u32 v72, v72, v74
    s_cmp_ge_u32 s68, s67
    s_cbranch_scc1 Lck_100
    s_nop 4
Lwf_101:
    ds_read_b128 v[36:39], v102 offset:0
    s_waitcnt lgkmcnt(0)
    v_min3_u32 v36, v36, v37, v38
    v_min_u32 v36, v36, v39
    s_nop 0
    v_readfirstlane_b32 s68, v36
    s_nop 1
    s_cmp_ge_u32 s68, s67
    s_nop 1
    s_cbranch_scc1 Lwfd_102
    s_sub_u32 s56, s56, 1
    s_cmp_eq_u32 s56, 0
    s_mov_b32 s69, 2
    s_cbranch_scc1 L_ABORT
    s_branch Lwf_101
Lwfd_102:
Lck_100:
    s_cmp_eq_u32 s13, 0
    s_cbranch_scc1 Lop_103
    s_waitcnt vmcnt(5)
    ds_write_b32 v102, v99 offset:8
Lop_103:
    v_mfma_f32_16x16x32_bf16 v[4:7], v[196:199], v[48:51], v[4:7]
    ds_read2_b64 v[44:47], v98 offset0:128 offset1:144
    v_mfma_f32_16x16x32_bf16 v[0:3], v[200:203], v[52:55], v[0:3]
    ds_read_b128 v[36:39], v102 offset:48
    v_mfma_f32_16x16x32_bf16 v[4:7], v[204:207], v[52:55], v[4:7]
    ds_read_b128 v[48:51], v95 offset:19456
    s_waitcnt lgkmcnt(6)
    v_mfma_f32_16x16x32_bf16 v[0:3], v[208:211], v[56:59], v[0:3]
    v_mfma_f32_16x16x32_bf16 v[4:7], v[212:215], v[56:59], v[4:7]
    ds_read_b128 v[52:55], v95 offset:20480
    s_mov_b32 s67, s55
    v_mfma_f32_16x16x32_bf16 v[0:3], v[216:219], v[60:63], v[0:3]
    s_add_u32 s66, s57, 4
    s_waitcnt lgkmcnt(2)
    v_min3_u32 v36, v36, v37, v38
    v_mfma_f32_16x16x32_bf16 v[4:7], v[220:223], v[60:63], v[4:7]
    ds_read_b128 v[56:59], v95 offset:21504
    s_waitcnt lgkmcnt(6)
    v_mfma_f32_16x16x32_bf16 v[0:3], v[224:227], v[64:67], v[0:3]
    v_mov_b32 v99, s66
    v_min_u32 v36, v36, v39
    v_mfma_f32_16x16x32_bf16 v[4:7], v[228:231], v[64:67], v[4:7]
    ds_read_b128 v[60:63], v95 offset:22528
    s_cmp_eq_u32 s13, 0
    s_cbranch_scc1 Lop_104
    s_waitcnt vmcnt(0)
    ds_write_b32 v102, v99 offset:8
Lop_104:
    v_mfma_f32_16x16x32_bf16 v[0:3], v[232:235], v[68:71], v[0:3]
    v_readfirstlane_b32 s68, v36
    v_mfma_f32_16x16x32_bf16 v[4:7], v[236:239], v[68:71], v[4:7]
    ds_read_b128 v[64:67], v95 offset:23552
    s_waitcnt lgkmcnt(6)
    v_mfma_f32_16x16x32_bf16 v[0:3], v[240:243], v[40:43], v[0:3]
    s_cmp_ge_u32 s68, s67
    s_cbranch_scc1 Lck_105
    s_nop 6
Lwf_106:
    ds_read_b128 v[36:39], v102 offset:48
    s_waitcnt lgkmcnt(0)
    v_min3_u32 v36, v36, v37, v38
    v_min_u32 v36, v36, v39
    s_nop 0
    v_readfirstlane_b32 s68, v36
    s_nop 1
    s_cmp_ge_u32 s68, s67
    s_nop 1
    s_cbranch_scc1 Lwfd_107
    s_sub_u32 s56, s56, 1
    s_cmp_eq_u32 s56, 0
    s_mov_b32 s69, 3
    s_cbranch_scc1 L_ABORT
    s_branch Lwf_106
Lwfd_107:
Lck_105:
    v_mfma_f32_16x16x32_bf16 v[4:7], v[244:247], v[40:43], v[4:7]
    ds_read_b128 v[68:71], v95 offset:24576
    v_mfma_f32_16x16x32_bf16 v[0:3], v[248:251], v[44:47], v[0:3]
    v_mfma_f32_16x16x32_bf16 v[4:7], v[252:255], v[44:47], v[4:7]
    ds_read_b128 v[40:43], v95 offset:25600
    s_waitcnt lgkmcnt(5)
    v_mfma_f32_16x16x32_bf16 v[8:11], v[112:115], v[48:51], 0
    v_mfma_f32_16x16x32_bf16 v[12:15], v[116:119], v[48:51], 0
    ds_read_b128 v[44:47], v95 offset:26624
    v_mfma_f32_16x16x32_bf16 v[8:11], v[120:123], v[52:55], v[8:11]
    v_mfma_f32_16x16x32_bf16 v[12:15], v[124:127], v[52:55], v[12:15]
    ds_read_b128 v[48:51], v95 offset:27648
    s_waitcnt lgkmcnt(5)
    v_mfma_f32_16x16x32_bf16 v[8:11], v[128:131], v[56:59], v[8:11]
    v_mfma_f32_16x16x32_bf16 v[12:15], v[132:135], v[56:59], v[12:15]
    ds_read_b128 v[52:55], v95 offset:28672
    v_mfma_f32_16x16x32_bf16 v[8:11], v[136:139], v[60:63], v[8:11]
    ds_bpermute_b32 v74, v73, v2
    v_mfma_f32_16x16x32_bf16 v[12:15], v[140:143], v[60:63], v[12:15]
    ds_read_b128 v[56:59], v95 offset:29696
    s_waitcnt lgkmcnt(6)
    v_mfma_f32_16x16x32_bf16 v[8:11], v[144:147], v[64:67], v[8:11]
    v_mfma_f32_16x16x32_bf16 v[12:15], v[148:151], v[64:67], v[12:15]
    ds_read_b128 v[60:63], v95 offset:30720
    s_waitcnt lgkmcnt(2)
    v_mul_f32 v74, 0xbae38e39, v74
    v_mfma_f32_16x16x32_bf16 v[8:11], v[152:155], v[68:71], v[8:11]
    v_fma_f32 v0, v74, v104, v0
    v_fma_f32 v1, v74, v105, v1
    v_mfma_f32_16x16x32_bf16 v[12:15], v[156:159], v[68:71], v[12:15]
    ds_read_b128 v[64:67], v95 offset:31744
    s_waitcnt lgkmcnt(6)
    v_mfma_f32_16x16x32_bf16 v[8:11], v[160:163], v[40:43], v[8:11]
    v_fma_f32 v2, v74, v106, v2
    v_fma_f32 v3, v74, v107, v3
    v_fma_f32 v4, v74, v108, v4
    v_mfma_f32_16x16x32_bf16 v[12:15], v[164:167], v[40:43], v[12:15]
    ds_read_b128 v[68:71], v95 offset:32768
    v_fma_f32 v5, v74, v109, v5
    v_mfma_f32_16x16x32_bf16 v[8:11], v[168:171], v[44:47], v[8:11]
    ds_read_b128 v[36:39], v102 offset:0
    v_fma_f32 v6, v74, v110, v6
    v_fma_f32 v7, v74, v111, v7
    v_mfma_f32_16x16x32_bf16 v[12:15], v[172:175], v[44:47], v[12:15]
    ds_read_b128 v[40:43], v95 offset:33792
    s_waitcnt lgkmcnt(7)
    v_mfma_f32_16x16x32_bf16 v[8:11], v[176:179], v[48:51], v[8:11]
    v_cvt_pk_bf16_f32 v0, v0, v4
    v_cvt_pk_bf16_f32 v1, v1, v5
    s_add_u32 s67, s57, 3
    v_cvt_pk_bf16_f32 v2, v2, v6
    v_mfma_f32_16x16x32_bf16 v[12:15], v[180:183], v[48:51], v[12:15]
    ds_read_b128 v[44:47], v95 offset:34816
    s_waitcnt lgkmcnt(2)
    v_min3_u32 v36, v36, v37, v38
    v_mfma_f32_16x16x32_bf16 v[8:11], v[184:187], v[52:55], v[8:11]
    v_cvt_pk_bf16_f32 v3, v3, v7
    v_min_u32 v36, v36, v39
    s_mov_b32 exec_lo, 0xff00ff00
    s_mov_b32 exec_hi, 0xff00ff00
    buffer_store_dwordx4 v[0:3], v88, s[40:43], s83 offen sc1
    s_mov_b64 exec, -1
    ds_write_b128 v72, v[0:3] offset:17408
    v_mfma_f32_16x16x32_bf16 v[12:15], v[188:191], v[52:55], v[12:15]
    v_add_u32 v98, 19456, v97
    ds_read2_b64 v[48:51], v98 offset0:0 offset1:16
    s_waitcnt lgkmcnt(7)
    v_mfma_f32_16x16x32_bf16 v[8:11], v[192:195], v[56:59], v[8:11]
    v_readfirstlane_b32 s68, v36
    s_cmp_ge_u32 s68, s67
    s_cbranch_scc1 Lck_108
    s_nop 5
Lwf_109:
    ds_read_b128 v[36:39], v102 offset:0
    s_waitcnt lgkmcnt(0)
    v_min3_u32 v36, v36, v37, v38
    v_min_u32 v36, v36, v39
    s_nop 0
    v_readfirstlane_b32 s68, v36
    s_nop 1
    s_cmp_ge_u32 s68, s67
    s_nop 1
    s_cbranch_scc1 Lwfd_110
    s_sub_u32 s56, s56, 1
    s_cmp_eq_u32 s56, 0
    s_mov_b32 s69, 2
    s_cbranch_scc1 L_ABORT
    s_branch Lwf_109
Lwfd_110:
Lck_108:
    v_mfma_f32_16x16x32_bf16 v[12:15], v[196:199], v[56:59], v[12:15]
    ds_read2_b64 v[52:55], v98 offset0:128 offset1:144
    v_mfma_f32_16x16x32_bf16 v[8:11], v[200:203], v[60:63], v[8:11]
    v_mfma_f32_16x16x32_bf16 v[12:15], v[204:207], v[60:63], v[12:15]
    ds_read_b128 v[56:59], v96 offset:0
    s_waitcnt lgkmcnt(7)
    v_mfma_f32_16x16x32_bf16 v[8:11], v[208:211], v[64:67], v[8:11]
    v_mfma_f32_16x16x32_bf16 v[12:15], v[212:215], v[64:67], v[12:15]
    ds_read_b128 v[60:63], v96 offset:1024
    v_mfma_f32_16x16x32_bf16 v[8:11], v[216:219], v[68:71], v[8:11]
    v_mfma_f32_16x16x32_bf16 v[12:15], v[220:223], v[68:71], v[12:15]
    ds_read_b128 v[64:67], v96 offset:2048
    s_waitcnt lgkmcnt(6)
    v_mfma_f32_16x16x32_bf16 v[8:11], v[224:227], v[40:43], v[8:11]
    v_mfma_f32_16x16x32_bf16 v[12:15], v[228:231], v[40:43], v[12:15]
    ds_read_b128 v[68:71], v96 offset:3072
    v_mfma_f32_16x16x32_bf16 v[8:11], v[232:235], v[44:47], v[8:11]
    v_mfma_f32_16x16x32_bf16 v[12:15], v[236:239], v[44:47], v[12:15]
    ds_read_b128 v[40:43], v96 offset:4096
    s_waitcnt lgkmcnt(5)
    v_mfma_f32_16x16x32_bf16 v[8:11], v[240:243], v[48:51], v[8:11]
    v_mfma_f32_16x16x32_bf16 v[12:15], v[244:247], v[48:51], v[12:15]
    ds_read_b128 v[44:47], v96 offset:5120
    v_mfma_f32_16x16x32_bf16 v[8:11], v[248:251], v[52:55], v[8:11]
    v_mfma_f32_16x16x32_bf16 v[12:15], v[252:255], v[52:55], v[12:15]
    ds_read_b128 v[48:51], v96 offset:6144
    s_waitcnt lgkmcnt(5)
    v_mfma_f32_16x16x32_bf16 v[16:19], v[112:115], v[56:59], 0
    v_mfma_f32_16x16x32_bf16 v[20:23], v[116:119], v[56:59], 0
    ds_read_b128 v[52:55], v96 offset:7168
    v_mfma_f32_16x16x32_bf16 v[16:19], v[120:123], v[60:63], v[16:19]
    v_mfma_f32_16x16x32_bf16 v[20:23], v[124:127], v[60:63], v[20:23]
    ds_read_b128 v[56:59], v96 offset:8192
    s_waitcnt lgkmcnt(5)
    v_mfma_f32_16x16x32_bf16 v[16:19], v[128:131], v[64:67], v[16:19]
    v_mfma_f32_16x16x32_bf16 v[20:23], v[132:135], v[64:67], v[20:23]
    ds_read_b128 v[60:63], v96 offset:9216
    v_mfma_f32_16x16x32_bf16 v[16:19], v[136:139], v[68:71], v[16:19]
    ds_read_b128 v[36:39], v102 offset:0
    v_mfma_f32_16x16x32_bf16 v[20:23], v[140:143], v[68:71], v[20:23]
    ds_read_b128 v[64:67], v96 offset:10240
    s_waitcnt lgkmcnt(6)
    v_mfma_f32_16x16x32_bf16 v[16:19], v[144:147], v[40:43], v[16:19]
    v_mfma_f32_16x16x32_bf16 v[20:23], v[148:151], v[40:43], v[20:23]
    ds_read_b128 v[68:71], v96 offset:11264
    s_add_u32 s67, s57, 4
    v_mfma_f32_16x16x32_bf16 v[16:19], v[152:155], v[44:47], v[16:19]
    s_waitcnt lgkmcnt(2)
    v_min3_u32 v36, v36, v37, v38
    v_min_u32 v36, v36, v39
    v_mfma_f32_16x16x32_bf16 v[20:23], v[156:159], v[44:47], v[20:23]
    ds_read_b128 v[40:43], v96 offset:12288
    s_waitcnt lgkmcnt(6)
    v_mfma_f32_16x16x32_bf16 v[16:19], v[160:163], v[48:51], v[16:19]
    v_readfirstlane_b32 s68, v36
    v_mfma_f32_16x16x32_bf16 v[20:23], v[164:167], v[48:51], v[20:23]
    ds_read_b128 v[44:47], v96 offset:13312
    v_mfma_f32_16x16x32_bf16 v[16:19], v[168:171], v[52:55], v[16:19]
    s_cmp_ge_u32 s68, s67
    s_cbranch_scc1 Lck_111
    s_nop 6
Lwf_112:
    ds_read_b128 v[36:39], v102 offset:0
    s_waitcnt lgkmcnt(0)
    v_min3_u32 v36, v36, v37, v38
    v_min_u32 v36, v36, v39
    s_nop 0
    v_readfirstlane_b32 s68, v36
    s_nop 1
    s_cmp_ge_u32 s68, s67
    s_nop 1
    s_cbranch_scc1 Lwfd_113
    s_sub_u32 s56, s56, 1
    s_cmp_eq_u32 s56, 0
    s_mov_b32 s69, 2
    s_cbranch_scc1 L_ABORT
    s_branch Lwf_112
Lwfd_113:
Lck_111:
    v_lshrrev_b32 v32, 4, v103
    v_mfma_f32_16x16x32_bf16 v[20:23], v[172:175], v[52:55], v[20:23]
    ds_read_b128 v[48:51], v96 offset:14336
    s_waitcnt lgkmcnt(6)
    v_mfma_f32_16x16x32_bf16 v[16:19], v[176:179], v[56:59], v[16:19]
    v_lshl_add_u32 v32, v32, 8, v73
    v_add_u32 v32, 0xdf40, v32
    v_mfma_f32_16x16x32_bf16 v[20:23], v[180:183], v[56:59], v[20:23]
    ds_read_b128 v[52:55], v96 offset:15360
    ds_read2_b32 v[34:35], v32 offset0:32 offset1:48
    v_mfma_f32_16x16x32_bf16 v[16:19], v[184:187], v[60:63], v[16:19]
    ds_read2_b32 v[32:33], v32 offset0:0 offset1:16
    v_mfma_f32_16x16x32_bf16 v[20:23], v[188:191], v[60:63], v[20:23]
    v_add_u32 v98, 38912, v97
    ds_read2_b64 v[56:59], v98 offset0:0 offset1:16
    s_waitcnt lgkmcnt(7)
    v_mfma_f32_16x16x32_bf16 v[16:19], v[192:195], v[64:67], v[16:19]
    v_mfma_f32_16x16x32_bf16 v[20:23], v[196:199], v[64:67], v[20:23]
    ds_read2_b64 v[60:63], v98 offset0:128 offset1:144
    s_waitcnt lgkmcnt(2)
    v_add_f32 v32, v32, v33
    v_mfma_f32_16x16x32_bf16 v[16:19], v[200:203], v[68:71], v[16:19]
    ds_bpermute_b32 v74, v73, v10
    v_add_f32 v34, v34, v35
    v_mfma_f32_16x16x32_bf16 v[20:23], v[204:207], v[68:71], v[20:23]
    ds_read_b128 v[64:67], v95 offset:0
    s_waitcnt lgkmcnt(8)
    v_mfma_f32_16x16x32_bf16 v[16:19], v[208:211], v[40:43], v[16:19]
    v_add_f32 v32, v32, v34
    v_mfma_f32_16x16x32_bf16 v[20:23], v[212:215], v[40:43], v[20:23]
    ds_read_b128 v[68:71], v95 offset:1024
    v_mfma_f32_16x16x32_bf16 v[16:19], v[216:219], v[44:47], v[16:19]
    v_mov_b32 v33, v32
    v_mfma_f32_16x16x32_bf16 v[20:23], v[220:223], v[44:47], v[20:23]
    ds_read_b128 v[40:43], v95 offset:2048
    s_waitcnt lgkmcnt(8)
    v_mfma_f32_16x16x32_bf16 v[16:19], v[224:227], v[48:51], v[16:19]
    v_permlane32_swap_b32 v32, v33
    v_mfma_f32_16x16x32_bf16 v[20:23], v[228:231], v[48:51], v[20:23]
    ds_read_b128 v[44:47], v95 offset:3072
    v_add_f32 v32, v32, v33
    v_mfma_f32_16x16x32_bf16 v[16:19], v[232:235], v[52:55], v[16:19]
    s_waitcnt lgkmcnt(4)
    v_mul_f32 v74, 0xbae38e39, v74
    v_mov_b32 v33, v32
    v_mfma_f32_16x16x32_bf16 v[20:23], v[236:239], v[52:55], v[20:23]
    ds_read_b128 v[48:51], v95 offset:4096
    s_waitcnt lgkmcnt(6)
    v_mfma_f32_16x16x32_bf16 v[16:19], v[240:243], v[56:59], v[16:19]
    v_fma_f32 v8, v74, v104, v8
    v_permlane16_swap_b32 v32, v33
    v_mfma_f32_16x16x32_bf16 v[20:23], v[244:247], v[56:59], v[20:23]
    ds_read_b128 v[52:55], v95 offset:5120
    v_fma_f32 v9, v74, v105, v9
    v_mfma_f32_16x16x32_bf16 v[16:19], v[248:251], v[60:63], v[16:19]
    v_add_f32 v32, v32, v33
    v_fma_f32 v10, v74, v106, v10
    v_mul_f32 v32, 0x3ae38e39, v32
    v_fma_f32 v11, v74, v107, v11
    v_mfma_f32_16x16x32_bf16 v[20:23], v[252:255], v[60:63], v[20:23]
    ds_read_b128 v[56:59], v95 offset:6144
    s_waitcnt lgkmcnt(5)
    v_mfma_f32_16x16x32_bf16 v[24:27], v[112:115], v[64:67], 0
    v_fma_f32 v12, v74, v108, v12
    v_fma_f32 v13, v74, v109, v13
    v_fma_f32 v14, v74, v110, v14
    v_mfma_f32_16x16x32_bf16 v[28:31], v[116:119], v[64:67], 0
    ds_read_b128 v[60:63], v95 offset:7168
    v_fma_f32 v15, v74, v111, v15
    v_mfma_f32_16x16x32_bf16 v[24:27], v[120:123], v[68:71], v[24:27]
    v_cvt_pk_bf16_f32 v8, v8, v12
    v_cvt_pk_bf16_f32 v9, v9, v13
    v_mfma_f32_16x16x32_bf16 v[28:31], v[124:127], v[68:71], v[28:31]
    ds_read_b128 v[64:67], v95 offset:8192
    s_waitcnt lgkmcnt(5)
    v_mfma_f32_16x16x32_bf16 v[24:27], v[128:131], v[40:43], v[24:27]
    v_cvt_pk_bf16_f32 v10, v10, v14
    v_cvt_pk_bf16_f32 v11, v11, v15
    ds_write_b128 v72, v[8:11] offset:8704
    v_mfma_f32_16x16x32_bf16 v[28:31], v[132:135], v[40:43], v[28:31]
    ds_read_b128 v[68:71], v95 offset:9216
    v_mfma_f32_16x16x32_bf16 v[24:27], v[136:139], v[44:47], v[24:27]
    ds_bpermute_b32 v74, v73, v18
    v_mfma_f32_16x16x32_bf16 v[28:31], v[140:143], v[44:47], v[28:31]
    ds_read_b128 v[40:43], v95 offset:10240
    s_waitcnt lgkmcnt(7)
    v_mfma_f32_16x16x32_bf16 v[24:27], v[144:147], v[48:51], v[24:27]
    v_mfma_f32_16x16x32_bf16 v[28:31], v[148:151], v[48:51], v[28:31]
    ds_read_b128 v[44:47], v95 offset:11264
    v_mfma_f32_16x16x32_bf16 v[24:27], v[152:155], v[52:55], v[24:27]
    v_add_u32 v34, 0x22700, v73
    s_waitcnt lgkmcnt(2)
    v_mul_f32 v74, 0xbae38e39, v74
    v_mfma_f32_16x16x32_bf16 v[28:31], v[156:159], v[52:55], v[28:31]
    ds_read_b128 v[48:51], v95 offset:12288
    s_waitcnt lgkmcnt(7)
    v_mfma_f32_16x16x32_bf16 v[24:27], v[160:163], v[56:59], v[24:27]
    v_fma_f32 v16, v74, v104, v16
    v_fma_f32 v17, v74, v105, v17
    v_mfma_f32_16x16x32_bf16 v[28:31], v[164:167], v[56:59], v[28:31]
    ds_read_b128 v[52:55], v95 offset:13312
    v_fma_f32 v18, v74, v106, v18
    v_mfma_f32_16x16x32_bf16 v[24:27], v[168:171], v[60:63], v[24:27]
    v_fma_f32 v19, v74, v107, v19
    v_fma_f32 v20, v74, v108, v20
    v_mfma_f32_16x16x32_bf16 v[28:31], v[172:175], v[60:63], v[28:31]
    ds_read_b128 v[56:59], v95 offset:14336
    s_waitcnt lgkmcnt(6)
    v_mfma_f32_16x16x32_bf16 v[24:27], v[176:179], v[64:67], v[24:27]
    v_fma_f32 v21, v74, v109, v21
    v_fma_f32 v22, v74, v110, v22
    v_mfma_f32_16x16x32_bf16 v[28:31], v[180:183], v[64:67], v[28:31]
    ds_read_b128 v[60:63], v95 offset:15360
    v_fma_f32 v23, v74, v111, v23
    v_mfma_f32_16x16x32_bf16 v[24:27], v[184:187], v[68:71], v[24:27]
    v_cvt_pk_bf16_f32 v16, v16, v20
    v_cvt_pk_bf16_f32 v17, v17, v21
    v_mfma_f32_16x16x32_bf16 v[28:31], v[188:191], v[68:71], v[28:31]
    v_add_u32 v98, 0, v97
    ds_read2_b64 v[64:67], v98 offset0:0 offset1:16
    s_waitcnt lgkmcnt(5)
    v_mfma_f32_16x16x32_bf16 v[24:27], v[192:195], v[40:43], v[24:27]
    v_cvt_pk_bf16_f32 v18, v18, v22
    v_cvt_pk_bf16_f32 v19, v19, v23
    v_mfma_f32_16x16x32_bf16 v[28:31], v[196:199], v[40:43], v[28:31]
    ds_read2_b64 v[68:71], v98 offset0:128 offset1:144
    ds_write_b128 v72, v[16:19] offset:13056
    v_mfma_f32_16x16x32_bf16 v[24:27], v[200:203], v[44:47], v[24:27]
    v_fma_f32 v32, -v74, v74, v32
    v_max_f32 v32, 0, v32
    v_mfma_f32_16x16x32_bf16 v[28:31], v[204:207], v[44:47], v[28:31]
    v_add_f32 v32, 0x3727c5ac, v32
    s_waitcnt lgkmcnt(5)
    v_mfma_f32_16x16x32_bf16 v[24:27], v[208:211], v[48:51], v[24:27]
    v_rsq_f32 v32, v32
    s_mov_b64 exec, 0xffff
    ds_write_b32 v34, v32
    s_mov_b64 exec, -1
    v_mfma_f32_16x16x32_bf16 v[28:31], v[212:215], v[48:51], v[28:31]
    v_mfma_f32_16x16x32_bf16 v[24:27], v[216:219], v[52:55], v[24:27]
    v_mfma_f32_16x16x32_bf16 v[28:31], v[220:223], v[52:55], v[28:31]
    s_waitcnt lgkmcnt(4)
    v_mfma_f32_16x16x32_bf16 v[24:27], v[224:227], v[56:59], v[24:27]
    v_mfma_f32_16x16x32_bf16 v[28:31], v[228:231], v[56:59], v[28:31]
    v_mfma_f32_16x16x32_bf16 v[24:27], v[232:235], v[60:63], v[24:27]
    v_mfma_f32_16x16x32_bf16 v[28:31], v[236:239], v[60:63], v[28:31]
    s_waitcnt lgkmcnt(2)
    v_mfma_f32_16x16x32_bf16 v[24:27], v[240:243], v[64:67], v[24:27]
    v_mfma_f32_16x16x32_bf16 v[28:31], v[244:247], v[64:67], v[28:31]
    v_mfma_f32_16x16x32_bf16 v[24:27], v[248:251], v[68:71], v[24:27]
    v_mfma_f32_16x16x32_bf16 v[28:31], v[252:255], v[68:71], v[28:31]
    s_mov_b32 s13, 0
    s_setprio 2
    s_add_u32 s66, s55, 1
    v_mov_b32 v99, s66
    ds_write_b32 v102, v99 offset:24
    s_nop 1
    ds_bpermute_b32 v74, v73, v26
    s_waitcnt lgkmcnt(0)
    v_mul_f32 v74, 0xbae38e39, v74
    v_fma_f32 v24, v74, v104, v24
    v_fma_f32 v25, v74, v105, v25
    v_fma_f32 v26, v74, v106, v26
    v_fma_f32 v27, v74, v107, v27
    v_fma_f32 v28, v74, v108, v28
    v_fma_f32 v29, v74, v109, v29
    v_fma_f32 v30, v74, v110, v30
    v_fma_f32 v31, v74, v111, v31
    v_cvt_pk_bf16_f32 v24, v24, v28
    v_cvt_pk_bf16_f32 v25, v25, v29
    v_cvt_pk_bf16_f32 v26, v26, v30
    v_cvt_pk_bf16_f32 v27, v27, v31
    ds_write_b128 v72, v[24:27] offset:4352
    s_waitcnt lgkmcnt(0)
    s_add_u32 s66, s55, 1
    v_mov_b32 v99, s66
    ds_write_b32 v102, v99 offset:40
    s_cmp_lg_u32 s55, 0
    s_nop 0
    s_cbranch_scc1 Lknf_114
    s_mov_b32 s67, 2
Lwf_115:
    ds_read_b128 v[40:43], v102 offset:128
    s_waitcnt lgkmcnt(0)
    v_min3_u32 v40, v40, v41, v42
    v_min_u32 v40, v40, v43
    s_nop 0
    v_readfirstlane_b32 s68, v40
    s_nop 1
    s_cmp_ge_u32 s68, s67
    s_nop 1
    s_cbranch_scc1 Lwfd_116
    s_sub_u32 s56, s56, 1
    s_cmp_eq_u32 s56, 0
    s_mov_b32 s69, 21
    s_cbranch_scc1 L_ABORT
    s_branch Lwf_115
Lwfd_116:
    v_and_b32 v44, 15, v103
    v_lshlrev_b32 v44, 4, v44
    v_add_u32 v45, 256, v44
    v_and_b32 v46, 16, v103
    s_cmp_eq_u32 s51, 0
    s_cselect_b32 s60, 0, 16
    v_and_b32 v46, s60, v46
    v_cmp_eq_u32 s[62:63], 0, v46
    s_nop 1
    v_cndmask_b32 v44, v44, v45, s[62:63]
    s_lshl_b32 s60, s51, 8
    s_add_u32 s60, s60, 21298944
    s_nop 0
Lini_117:
    buffer_load_dwordx4 v[40:43], v44, s[40:43], s60 offen sc1
    s_waitcnt vmcnt(0)
    v_xor_b32 v40, s58, v40
    v_xor_b32 v41, s59, v41
    v_xor_b32 v43, s58, v43
    v_or3_b32 v40, v40, v41, v43
    v_cmp_ne_u32 vcc, 0, v40
    s_nop 1
    s_cmp_eq_u64 vcc, 0
    s_nop 1
    s_cbranch_scc1 Linid_118
    s_sub_u32 s56, s56, 1
    s_cmp_eq_u32 s56, 0
    s_mov_b32 s69, 8
    s_cbranch_scc1 L_ABORT
    s_sleep 2
    s_branch Lini_117
Linid_118:
    v_cmp_ne_u32 vcc, s93, v42
    s_nop 1
    s_and_b64 vcc, vcc, s[62:63]
    s_cmp_eq_u64 vcc, 0
    s_cselect_b32 s85, 1, 0
Lknf_114:
    s_branch L_M_EPI
L_A_W3:
    v_add_u32 v98, 58368, v97
    ds_read_b128 v[40:43], v96 offset:19456
    ds_read_b128 v[44:47], v96 offset:20480
    ds_read_b128 v[48:51], v96 offset:21504
    ds_read_b128 v[52:55], v96 offset:22528
    ds_read_b128 v[56:59], v96 offset:23552
    ds_read_b128 v[60:63], v96 offset:24576
    ds_read_b128 v[64:67], v96 offset:25600
    s_waitcnt lgkmcnt(5)
    v_mfma_f32_16x16x32_bf16 v[0:3], v[112:115], v[40:43], 0
    v_and_b32 v74, 15, v103
    v_add_u32 v73, 48, v74
    v_mfma_f32_16x16x32_bf16 v[4:7], v[116:119], v[40:43], 0
    ds_read_b128 v[68:71], v96 offset:26624
    v_lshlrev_b32 v73, 2, v73
    v_mfma_f32_16x16x32_bf16 v[0:3], v[120:123], v[44:47], v[0:3]
    s_add_u32 s66, s57, 2
    v_mov_b32 v99, s66
    v_mfma_f32_16x16x32_bf16 v[4:7], v[124:127], v[44:47], v[4:7]
    ds_read_b128 v[40:43], v96 offset:27648
    s_waitcnt lgkmcnt(5)
    v_mfma_f32_16x16x32_bf16 v[0:3], v[128:131], v[48:51], v[0:3]
    s_cmp_eq_u32 s13, 0
    s_cbranch_scc1 Lop_119
    s_waitcnt vmcnt(10)
    ds_write_b32 v102, v99 offset:12
Lop_119:
    v_lshrrev_b32 v75, 4, v103
    v_mfma_f32_16x16x32_bf16 v[4:7], v[132:135], v[48:51], v[4:7]
    ds_read_b128 v[44:47], v96 offset:28672
    v_lshlrev_b32 v75, 3, v75
    v_mfma_f32_16x16x32_bf16 v[0:3], v[136:139], v[52:55], v[0:3]
    s_mov_b32 s65, 0xf0e0a060
    v_bfe_u32 v72, s65, v75, 8
    v_mfma_f32_16x16x32_bf16 v[4:7], v[140:143], v[52:55], v[4:7]
    ds_read_b128 v[48:51], v96 offset:29696
    s_waitcnt lgkmcnt(5)
    v_mfma_f32_16x16x32_bf16 v[0:3], v[144:147], v[56:59], v[0:3]
    v_and_b32 v88, 7, v103
    v_lshl_add_u32 v88, v88, 8, v72
    v_mfma_f32_16x16x32_bf16 v[4:7], v[148:151], v[56:59], v[4:7]
    ds_read_b128 v[52:55], v96 offset:30720
    v_mul_u32_u24 v74, 272, v74
    v_mfma_f32_16x16x32_bf16 v[0:3], v[152:155], v[60:63], v[0:3]
    s_cmp_eq_u32 s7, 0
    s_cbranch_scc1 Lnopub_120
    s_mov_b32 s7, 0
    s_mov_b32 s54, 0
    s_cmp_eq_u32 s85, 0
    s_nop 3
    s_cbranch_scc1 Lslow_121
    s_lshl_b32 s60, s54, 9
    s_add_u32 s60, s60, s12
    s_lshl_b32 s61, s52, 3
    s_add_u32 s60, s60, s61
    s_add_u32 s61, s58, s53
    s_add_u32 s61, s61, 1
    v_mov_b32 v92, s61
    v_mov_b32 v93, s59
    v_mov_b32 v94, 0
    s_mov_b64 exec, 1
    s_waitcnt vmcnt(0)
    buffer_store_dwordx2 v[92:93], v94, s[40:43], s60 offen
    s_mov_b64 exec, -1
    s_branch Lmend_122
Lslow_121:
    s_lshl_b32 s60, s54, 9
    s_add_u32 s60, s60, s12
    s_lshl_b32 s61, s52, 3
    s_add_u32 s60, s60, s61
    s_add_u32 s61, s58, s53
    s_add_u32 s61, s61, 1
    v_mov_b32 v92, s61
    v_mov_b32 v93, s59
    v_mov_b32 v94, 0
    s_mov_b64 exec, 1
    s_waitcnt vmcnt(0)
    buffer_store_dwordx2 v[92:93], v94, s[40:43], s60 offen sc1
    s_mov_b64 exec, -1
Lmend_122:
    s_mov_b32 s54, 1
Lnopub_120:
    ds_read_b128 v[36:39], v102 offset:0
    v_mfma_f32_16x16x32_bf16 v[4:7], v[156:159], v[60:63], v[4:7]
    ds_read_b128 v[56:59], v96 offset:31744
    s_waitcnt lgkmcnt(6)
    v_mfma_f32_16x16x32_bf16 v[0:3], v[160:163], v[64:67], v[0:3]
    v_mfma_f32_16x16x32_bf16 v[4:7], v[164:167], v[64:67], v[4:7]
    ds_read_b128 v[60:63], v96 offset:32768
    v_mfma_f32_16x16x32_bf16 v[0:3], v[168:171], v[68:71], v[0:3]
    s_add_u32 s67, s57, 2
    s_waitcnt lgkmcnt(2)
    v_min3_u32 v36, v36, v37, v38
    v_mfma_f32_16x16x32_bf16 v[4:7], v[172:175], v[68:71], v[4:7]
    ds_read_b128 v[64:67], v96 offset:33792
    s_waitcnt lgkmcnt(6)
    v_mfma_f32_16x16x32_bf16 v[0:3], v[176:179], v[40:43], v[0:3]
    v_min_u32 v36, v36, v39
    v_mfma_f32_16x16x32_bf16 v[4:7], v[180:183], v[40:43], v[4:7]
    ds_read_b128 v[68:71], v96 offset:34816
    v_readfirstlane_b32 s68, v36
    v_mfma_f32_16x16x32_bf16 v[0:3], v[184:187], v[44:47], v[0:3]
    s_add_u32 s66, s57, 3
    v_add_u32 v74, 0x13000, v74
    v_mfma_f32_16x16x32_bf16 v[4:7], v[188:191], v[44:47], v[4:7]
    ds_read2_b64 v[40:43], v98 offset0:0 offset1:16
    s_waitcnt lgkmcnt(6)
    v_mfma_f32_16x16x32_bf16 v[0:3], v[192:195], v[48:51], v[0:3]
    v_mov_b32 v99, s66
    v_add_u32 v72, v72, v74
    s_cmp_ge_u32 s68, s67
    s_cbranch_scc1 Lck_123
    s_nop 4
Lwf_124:
    ds_read_b128 v[36:39], v102 offset:0
    s_waitcnt lgkmcnt(0)
    v_min3_u32 v36, v36, v37, v38
    v_min_u32 v36, v36, v39
    s_nop 0
    v_readfirstlane_b32 s68, v36
    s_nop 1
    s_cmp_ge_u32 s68, s67
    s_nop 1
    s_cbranch_scc1 Lwfd_125
    s_sub_u32 s56, s56, 1
    s_cmp_eq_u32 s56, 0
    s_mov_b32 s69, 2
    s_cbranch_scc1 L_ABORT
    s_branch Lwf_124
Lwfd_125:
Lck_123:
    s_cmp_eq_u32 s13, 0
    s_cbranch_scc1 Lop_126
    s_waitcnt vmcnt(5)
    ds_write_b32 v102, v99 offset:12
Lop_126:
    v_mfma_f32_16x16x32_bf16 v[4:7], v[196:199], v[48:51], v[4:7]
    ds_read2_b64 v[44:47], v98 offset0:128 offset1:144
    v_mfma_f32_16x16x32_bf16 v[0:3], v[200:203], v[52:55], v[0:3]
    ds_read_b128 v[36:39], v102 offset:48
    v_mfma_f32_16x16x32_bf16 v[4:7], v[204:207], v[52:55], v[4:7]
    ds_read_b128 v[48:51], v95 offset:19456
    s_waitcnt lgkmcnt(6)
    v_mfma_f32_16x16x32_bf16 v[0:3], v[208:211], v[56:59], v[0:3]
    v_mfma_f32_16x16x32_bf16 v[4:7], v[212:215], v[56:59], v[4:7]
    ds_read_b128 v[52:55], v95 offset:20480
    s_mov_b32 s67, s55
    v_mfma_f32_16x16x32_bf16 v[0:3], v[216:219], v[60:63], v[0:3]
    s_add_u32 s66, s57, 4
    s_waitcnt lgkmcnt(2)
    v_min3_u32 v36, v36, v37, v38
    v_mfma_f32_16x16x32_bf16 v[4:7], v[220:223], v[60:63], v[4:7]
    ds_read_b128 v[56:59], v95 offset:21504
    s_waitcnt lgkmcnt(6)
    v_mfma_f32_16x16x32_bf16 v[0:3], v[224:227], v[64:67], v[0:3]
    v_mov_b32 v99, s66
    v_min_u32 v36, v36, v39
    v_mfma_f32_16x16x32_bf16 v[4:7], v[228:231], v[64:67], v[4:7]
    ds_read_b128 v[60:63], v95 offset:22528
    s_cmp_eq_u32 s13, 0
    s_cbranch_scc1 Lop_127
    s_waitcnt vmcnt(0)
    ds_write_b32 v102, v99 offset:12
Lop_127:
    v_mfma_f32_16x16x32_bf16 v[0:3], v[232:235], v[68:71], v[0:3]
    v_readfirstlane_b32 s68, v36
    v_mfma_f32_16x16x32_bf16 v[4:7], v[236:239], v[68:71], v[4:7]
    ds_read_b128 v[64:67], v95 offset:23552
    s_waitcnt lgkmcnt(6)
    v_mfma_f32_16x16x32_bf16 v[0:3], v[240:243], v[40:43], v[0:3]
    s_cmp_ge_u32 s68, s67
    s_cbranch_scc1 Lck_128
    s_nop 6
Lwf_129:
    ds_read_b128 v[36:39], v102 offset:48
    s_waitcnt lgkmcnt(0)
    v_min3_u32 v36, v36, v37, v38
    v_min_u32 v36, v36, v39
    s_nop 0
    v_readfirstlane_b32 s68, v36
    s_nop 1
    s_cmp_ge_u32 s68, s67
    s_nop 1
    s_cbranch_scc1 Lwfd_130
    s_sub_u32 s56, s56, 1
    s_cmp_eq_u32 s56, 0
    s_mov_b32 s69, 3
    s_cbranch_scc1 L_ABORT
    s_branch Lwf_129
Lwfd_130:
Lck_128:
    v_mfma_f32_16x16x32_bf16 v[4:7], v[244:247], v[40:43], v[4:7]
    ds_read_b128 v[68:71], v95 offset:24576
    v_mfma_f32_16x16x32_bf16 v[0:3], v[248:251], v[44:47], v[0:3]
    v_mfma_f32_16x16x32_bf16 v[4:7], v[252:255], v[44:47], v[4:7]
    ds_read_b128 v[40:43], v95 offset:25600
    s_waitcnt lgkmcnt(5)
    v_mfma_f32_16x16x32_bf16 v[8:11], v[112:115], v[48:51], 0
    v_mfma_f32_16x16x32_bf16 v[12:15], v[116:119], v[48:51], 0
    ds_read_b128 v[44:47], v95 offset:26624
    v_mfma_f32_16x16x32_bf16 v[8:11], v[120:123], v[52:55], v[8:11]
    v_mfma_f32_16x16x32_bf16 v[12:15], v[124:127], v[52:55], v[12:15]
    ds_read_b128 v[48:51], v95 offset:27648
    s_waitcnt lgkmcnt(5)
    v_mfma_f32_16x16x32_bf16 v[8:11], v[128:131], v[56:59], v[8:11]
    v_mfma_f32_16x16x32_bf16 v[12:15], v[132:135], v[56:59], v[12:15]
    ds_read_b128 v[52:55], v95 offset:28672
    v_mfma_f32_16x16x32_bf16 v[8:11], v[136:139], v[60:63], v[8:11]
    ds_bpermute_b32 v74, v73, v2
    v_mfma_f32_16x16x32_bf16 v[12:15], v[140:143], v[60:63], v[12:15]
    ds_read_b128 v[56:59], v95 offset:29696
    s_waitcnt lgkmcnt(6)
    v_mfma_f32_16x16x32_bf16 v[8:11], v[144:147], v[64:67], v[8:11]
    v_mfma_f32_16x16x32_bf16 v[12:15], v[148:151], v[64:67], v[12:15]
    ds_read_b128 v[60:63], v95 offset:30720
    s_waitcnt lgkmcnt(2)
    v_mul_f32 v74, 0xbae38e39, v74
    v_mfma_f32_16x16x32_bf16 v[8:11], v[152:155], v[68:71], v[8:11]
    v_fma_f32 v0, v74, v104, v0
    v_fma_f32 v1, v74, v105, v1
    v_mfma_f32_16x16x32_bf16 v[12:15], v[156:159], v[68:71], v[12:15]
    ds_read_b128 v[64:67], v95 offset:31744
    s_waitcnt lgkmcnt(6)
    v_mfma_f32_16x16x32_bf16 v[8:11], v[160:163], v[40:43], v[8:11]
    v_fma_f32 v2, v74, v106, v2
    v_fma_f32 v3, v74, v107, v3
    v_fma_f32 v4, v74, v108, v4
    v_mfma_f32_16x16x32_bf16 v[12:15], v[164:167], v[40:43], v[12:15]
    ds_read_b128 v[68:71], v95 offset:32768
    v_fma_f32 v5, v74, v109, v5
    v_mfma_f32_16x16x32_bf16 v[8:11], v[168:171], v[44:47], v[8:11]
    ds_read_b128 v[36:39], v102 offset:0
    v_fma_f32 v6, v74, v110, v6
    v_fma_f32 v7, v74, v111, v7
    v_mfma_f32_16x16x32_bf16 v[12:15], v[172:175], v[44:47], v[12:15]
    ds_read_b128 v[40:43], v95 offset:33792
    s_waitcnt lgkmcnt(7)
    v_mfma_f32_16x16x32_bf16 v[8:11], v[176:179], v[48:51], v[8:11]
    v_cvt_pk_bf16_f32 v0, v0, v4
    v_cvt_pk_bf16_f32 v1, v1, v5
    s_add_u32 s67, s57, 3
    v_cvt_pk_bf16_f32 v2, v2, v6
    v_mfma_f32_16x16x32_bf16 v[12:15], v[180:183], v[48:51], v[12:15]
    ds_read_b128 v[44:47], v95 offset:34816
    s_waitcnt lgkmcnt(2)
    v_min3_u32 v36, v36, v37, v38
    v_mfma_f32_16x16x32_bf16 v[8:11], v[184:187], v[52:55], v[8:11]
    v_cvt_pk_bf16_f32 v3, v3, v7
    v_min_u32 v36, v36, v39
    s_mov_b32 exec_lo, 0xff00ff00
    s_mov_b32 exec_hi, 0xff00ff00
    buffer_store_dwordx4 v[0:3], v88, s[40:43], s83 offen sc1
    s_mov_b64 exec, -1
    ds_write_b128 v72, v[0:3] offset:17408
    v_mfma_f32_16x16x32_bf16 v[12:15], v[188:191], v[52:55], v[12:15]
    v_add_u32 v98, 19456, v97
    ds_read2_b64 v[48:51], v98 offset0:0 offset1:16
    s_waitcnt lgkmcnt(7)
    v_mfma_f32_16x16x32_bf16 v[8:11], v[192:195], v[56:59], v[8:11]
    v_readfirstlane_b32 s68, v36
    s_cmp_ge_u32 s68, s67
    s_cbranch_scc1 Lck_131
    s_nop 5
Lwf_132:
    ds_read_b128 v[36:39], v102 offset:0
    s_waitcnt lgkmcnt(0)
    v_min3_u32 v36, v36, v37, v38
    v_min_u32 v36, v36, v39
    s_nop 0
    v_readfirstlane_b32 s68, v36
    s_nop 1
    s_cmp_ge_u32 s68, s67
    s_nop 1
    s_cbranch_scc1 Lwfd_133
    s_sub_u32 s56, s56, 1
    s_cmp_eq_u32 s56, 0
    s_mov_b32 s69, 2
    s_cbranch_scc1 L_ABORT
    s_branch Lwf_132
Lwfd_133:
Lck_131:
    v_mfma_f32_16x16x32_bf16 v[12:15], v[196:199], v[56:59], v[12:15]
    ds_read2_b64 v[52:55], v98 offset0:128 offset1:144
    v_mfma_f32_16x16x32_bf16 v[8:11], v[200:203], v[60:63], v[8:11]
    v_mfma_f32_16x16x32_bf16 v[12:15], v[204:207], v[60:63], v[12:15]
    ds_read_b128 v[56:59], v96 offset:0
    s_waitcnt lgkmcnt(7)
    v_mfma_f32_16x16x32_bf16 v[8:11], v[208:211], v[64:67], v[8:11]
    v_mfma_f32_16x16x32_bf16 v[12:15], v[212:215], v[64:67], v[12:15]
    ds_read_b128 v[60:63], v96 offset:1024
    v_mfma_f32_16x16x32_bf16 v[8:11], v[216:219], v[68:71], v[8:11]
    v_mfma_f32_16x16x32_bf16 v[12:15], v[220:223], v[68:71], v[12:15]
    ds_read_b128 v[64:67], v96 offset:2048
    s_waitcnt lgkmcnt(6)
    v_mfma_f32_16x16x32_bf16 v[8:11], v[224:227], v[40:43], v[8:11]
    v_mfma_f32_16x16x32_bf16 v[12:15], v[228:231], v[40:43], v[12:15]
    ds_read_b128 v[68:71], v96 offset:3072
    v_mfma_f32_16x16x32_bf16 v[8:11], v[232:235], v[44:47], v[8:11]
    v_mfma_f32_16x16x32_bf16 v[12:15], v[236:239], v[44:47], v[12:15]
    ds_read_b128 v[40:43], v96 offset:4096
    s_waitcnt lgkmcnt(5)
    v_mfma_f32_16x16x32_bf16 v[8:11], v[240:243], v[48:51], v[8:11]
    v_mfma_f32_16x16x32_bf16 v[12:15], v[244:247], v[48:51], v[12:15]
    ds_read_b128 v[44:47], v96 offset:5120
    v_mfma_f32_16x16x32_bf16 v[8:11], v[248:251], v[52:55], v[8:11]
    v_mfma_f32_16x16x32_bf16 v[12:15], v[252:255], v[52:55], v[12:15]
    ds_read_b128 v[48:51], v96 offset:6144
    s_waitcnt lgkmcnt(5)
    v_mfma_f32_16x16x32_bf16 v[16:19], v[112:115], v[56:59], 0
    v_mfma_f32_16x16x32_bf16 v[20:23], v[116:119], v[56:59], 0
    ds_read_b128 v[52:55], v96 offset:7168
    v_mfma_f32_16x16x32_bf16 v[16:19], v[120:123], v[60:63], v[16:19]
    v_mfma_f32_16x16x32_bf16 v[20:23], v[124:127], v[60:63], v[20:23]
    ds_read_b128 v[56:59], v96 offset:8192
    s_waitcnt lgkmcnt(5)
    v_mfma_f32_16x16x32_bf16 v[16:19], v[128:131], v[64:67], v[16:19]
    v_mfma_f32_16x16x32_bf16 v[20:23], v[132:135], v[64:67], v[20:23]
    ds_read_b128 v[60:63], v96 offset:9216
    v_mfma_f32_16x16x32_bf16 v[16:19], v[136:139], v[68:71], v[16:19]
    ds_read_b128 v[36:39], v102 offset:0
    v_mfma_f32_16x16x32_bf16 v[20:23], v[140:143], v[68:71], v[20:23]
    ds_read_b128 v[64:67], v96 offset:10240
    s_waitcnt lgkmcnt(6)
    v_mfma_f32_16x16x32_bf16 v[16:19], v[144:147], v[40:43], v[16:19]
    v_mfma_f32_16x16x32_bf16 v[20:23], v[148:151], v[40:43], v[20:23]
    ds_read_b128 v[68:71], v96 offset:11264
    s_add_u32 s67, s57, 4
    v_mfma_f32_16x16x32_bf16 v[16:19], v[152:155], v[44:47], v[16:19]
    s_waitcnt lgkmcnt(2)
    v_min3_u32 v36, v36, v37, v38
    v_min_u32 v36, v36, v39
    v_mfma_f32_16x16x32_bf16 v[20:23], v[156:159], v[44:47], v[20:23]
    ds_read_b128 v[40:43], v96 offset:12288
    s_waitcnt lgkmcnt(6)
    v_mfma_f32_16x16x32_bf16 v[16:19], v[160:163], v[48:51], v[16:19]
    v_readfirstlane_b32 s68, v36
    v_mfma_f32_16x16x32_bf16 v[20:23], v[164:167], v[48:51], v[20:23]
    ds_read_b128 v[44:47], v96 offset:13312
    v_mfma_f32_16x16x32_bf16 v[16:19], v[168:171], v[52:55], v[16:19]
    s_cmp_ge_u32 s68, s67
    s_cbranch_scc1 Lck_134
    s_nop 6
Lwf_135:
    ds_read_b128 v[36:39], v102 offset:0
    s_waitcnt lgkmcnt(0)
    v_min3_u32 v36, v36, v37, v38
    v_min_u32 v36, v36, v39
    s_nop 0
    v_readfirstlane_b32 s68, v36
    s_nop 1
    s_cmp_ge_u32 s68, s67
    s_nop 1
    s_cbranch_scc1 Lwfd_136
    s_sub_u32 s56, s56, 1
    s_cmp_eq_u32 s56, 0
    s_mov_b32 s69, 2
    s_cbranch_scc1 L_ABORT
    s_branch Lwf_135
Lwfd_136:
Lck_134:
    ds_bpermute_b32 v74, v73, v10
    v_mfma_f32_16x16x32_bf16 v[20:23], v[172:175], v[52:55], v[20:23]
    ds_read_b128 v[48:51], v96 offset:14336
    s_waitcnt lgkmcnt(7)
    v_mfma_f32_16x16x32_bf16 v[16:19], v[176:179], v[56:59], v[16:19]
    v_mfma_f32_16x16x32_bf16 v[20:23], v[180:183], v[56:59], v[20:23]
    ds_read_b128 v[52:55], v96 offset:15360
    v_mfma_f32_16x16x32_bf16 v[16:19], v[184:187], v[60:63], v[16:19]
    s_waitcnt lgkmcnt(2)
    v_mul_f32 v74, 0xbae38e39, v74
    v_mfma_f32_16x16x32_bf16 v[20:23], v[188:191], v[60:63], v[20:23]
    v_add_u32 v98, 38912, v97
    ds_read2_b64 v[56:59], v98 offset0:0 offset1:16
    s_waitcnt lgkmcnt(6)
    v_mfma_f32_16x16x32_bf16 v[16:19], v[192:195], v[64:67], v[16:19]
    v_fma_f32 v8, v74, v104, v8
    v_fma_f32 v9, v74, v105, v9
    v_mfma_f32_16x16x32_bf16 v[20:23], v[196:199], v[64:67], v[20:23]
    ds_read2_b64 v[60:63], v98 offset0:128 offset1:144
    v_fma_f32 v10, v74, v106, v10
    v_mfma_f32_16x16x32_bf16 v[16:19], v[200:203], v[68:71], v[16:19]
    v_fma_f32 v11, v74, v107, v11
    v_fma_f32 v12, v74, v108, v12
    v_mfma_f32_16x16x32_bf16 v[20:23], v[204:207], v[68:71], v[20:23]
    ds_read_b128 v[64:67], v95 offset:0
    s_waitcnt lgkmcnt(6)
    v_mfma_f32_16x16x32_bf16 v[16:19], v[208:211], v[40:43], v[16:19]
    v_fma_f32 v13, v74, v109, v13
    v_fma_f32 v14, v74, v110, v14
    v_mfma_f32_16x16x32_bf16 v[20:23], v[212:215], v[40:43], v[20:23]
    ds_read_b128 v[68:71], v95 offset:1024
    v_fma_f32 v15, v74, v111, v15
    v_mfma_f32_16x16x32_bf16 v[16:19], v[216:219], v[44:47], v[16:19]
    v_cvt_pk_bf16_f32 v8, v8, v12
    v_cvt_pk_bf16_f32 v9, v9, v13
    v_mfma_f32_16x16x32_bf16 v[20:23], v[220:223], v[44:47], v[20:23]
    ds_read_b128 v[40:43], v95 offset:2048
    s_waitcnt lgkmcnt(5)
    v_mfma_f32_16x16x32_bf16 v[16:19], v[224:227], v[48:51], v[16:19]
    v_cvt_pk_bf16_f32 v10, v10, v14
    v_cvt_pk_bf16_f32 v11, v11, v15
    v_mfma_f32_16x16x32_bf16 v[20:23], v[228:231], v[48:51], v[20:23]
    ds_read_b128 v[44:47], v95 offset:3072
    ds_write_b128 v72, v[8:11] offset:8704
    v_mfma_f32_16x16x32_bf16 v[16:19], v[232:235], v[52:55], v[16:19]
    v_mfma_f32_16x16x32_bf16 v[20:23], v[236:239], v[52:55], v[20:23]
    ds_read_b128 v[48:51], v95 offset:4096
    s_waitcnt lgkmcnt(6)
    v_mfma_f32_16x16x32_bf16 v[16:19], v[240:243], v[56:59], v[16:19]
    v_mfma_f32_16x16x32_bf16 v[20:23], v[244:247], v[56:59], v[20:23]
    ds_read_b128 v[52:55], v95 offset:5120
    v_mfma_f32_16x16x32_bf16 v[16:19], v[248:251], v[60:63], v[16:19]
    v_mfma_f32_16x16x32_bf16 v[20:23], v[252:255], v[60:63], v[20:23]
    ds_read_b128 v[56:59], v95 offset:6144
    s_waitcnt lgkmcnt(6)
    v_mfma_f32_16x16x32_bf16 v[24:27], v[112:115], v[64:67], 0
    v_mfma_f32_16x16x32_bf16 v[28:31], v[116:119], v[64:67], 0
    ds_read_b128 v[60:63], v95 offset:7168
    v_mfma_f32_16x16x32_bf16 v[24:27], v[120:123], v[68:71], v[24:27]
    v_mfma_f32_16x16x32_bf16 v[28:31], v[124:127], v[68:71], v[28:31]
    ds_read_b128 v[64:67], v95 offset:8192
    s_waitcnt lgkmcnt(6)
    v_mfma_f32_16x16x32_bf16 v[24:27], v[128:131], v[40:43], v[24:27]
    v_mfma_f32_16x16x32_bf16 v[28:31], v[132:135], v[40:43], v[28:31]
    ds_read_b128 v[68:71], v95 offset:9216
    v_mfma_f32_16x16x32_bf16 v[24:27], v[136:139], v[44:47], v[24:27]
    ds_bpermute_b32 v74, v73, v18
    v_mfma_f32_16x16x32_bf16 v[28:31], v[140:143], v[44:47], v[28:31]
    ds_read_b128 v[40:43], v95 offset:10240
    s_waitcnt lgkmcnt(6)
    v_mfma_f32_16x16x32_bf16 v[24:27], v[144:147], v[48:51], v[24:27]
    v_mfma_f32_16x16x32_bf16 v[28:31], v[148:151], v[48:51], v[28:31]
    ds_read_b128 v[44:47], v95 offset:11264
    v_mfma_f32_16x16x32_bf16 v[24:27], v[152:155], v[52:55], v[24:27]
    s_waitcnt lgkmcnt(2)
    v_mul_f32 v74, 0xbae38e39, v74
    v_fma_f32 v16, v74, v104, v16
    v_mfma_f32_16x16x32_bf16 v[28:31], v[156:159], v[52:55], v[28:31]
    ds_read_b128 v[48:51], v95 offset:12288
    s_waitcnt lgkmcnt(6)
    v_mfma_f32_16x16x32_bf16 v[24:27], v[160:163], v[56:59], v[24:27]
    v_lshrrev_b32 v32, 4, v103
    v_lshl_add_u32 v32, v32, 8, v73
    v_mfma_f32_16x16x32_bf16 v[28:31], v[164:167], v[56:59], v[28:31]
    ds_read_b128 v[52:55], v95 offset:13312
    v_add_u32 v32, 0x4740, v32
    v_mfma_f32_16x16x32_bf16 v[24:27], v[168:171], v[60:63], v[24:27]
    ds_read2_b32 v[34:35], v32 offset0:32 offset1:48
    ds_read2_b32 v[32:33], v32 offset0:0 offset1:16
    v_mfma_f32_16x16x32_bf16 v[28:31], v[172:175], v[60:63], v[28:31]
    ds_read_b128 v[56:59], v95 offset:14336
    s_waitcnt lgkmcnt(8)
    v_mfma_f32_16x16x32_bf16 v[24:27], v[176:179], v[64:67], v[24:27]
    v_mfma_f32_16x16x32_bf16 v[28:31], v[180:183], v[64:67], v[28:31]
    ds_read_b128 v[60:63], v95 offset:15360
    v_fma_f32 v17, v74, v105, v17
    v_mfma_f32_16x16x32_bf16 v[24:27], v[184:187], v[68:71], v[24:27]
    v_fma_f32 v18, v74, v106, v18
    v_mfma_f32_16x16x32_bf16 v[28:31], v[188:191], v[68:71], v[28:31]
    v_add_u32 v98, 0, v97
    ds_read2_b64 v[64:67], v98 offset0:0 offset1:16
    s_waitcnt lgkmcnt(7)
    v_mfma_f32_16x16x32_bf16 v[24:27], v[192:195], v[40:43], v[24:27]
    s_waitcnt lgkmcnt(3)
    v_add_f32 v32, v32, v33
    v_fma_f32 v19, v74, v107, v19
    v_mfma_f32_16x16x32_bf16 v[28:31], v[196:199], v[40:43], v[28:31]
    ds_read2_b64 v[68:71], v98 offset0:128 offset1:144
    v_add_f32 v34, v34, v35
    v_mfma_f32_16x16x32_bf16 v[24:27], v[200:203], v[44:47], v[24:27]
    v_fma_f32 v20, v74, v108, v20
    v_add_f32 v32, v32, v34
    v_mfma_f32_16x16x32_bf16 v[28:31], v[204:207], v[44:47], v[28:31]
    v_fma_f32 v21, v74, v109, v21
    s_waitcnt lgkmcnt(6)
    v_mfma_f32_16x16x32_bf16 v[24:27], v[208:211], v[48:51], v[24:27]
    v_mov_b32 v33, v32
    v_fma_f32 v22, v74, v110, v22
    v_mfma_f32_16x16x32_bf16 v[28:31], v[212:215], v[48:51], v[28:31]
    v_permlane32_swap_b32 v32, v33
    v_fma_f32 v23, v74, v111, v23
    v_mfma_f32_16x16x32_bf16 v[24:27], v[216:219], v[52:55], v[24:27]
    v_add_f32 v32, v32, v33
    v_cvt_pk_bf16_f32 v16, v16, v20
    v_mfma_f32_16x16x32_bf16 v[28:31], v[220:223], v[52:55], v[28:31]
    v_mov_b32 v33, v32
    s_waitcnt lgkmcnt(2)
    v_mfma_f32_16x16x32_bf16 v[24:27], v[224:227], v[56:59], v[24:27]
    v_cvt_pk_bf16_f32 v17, v17, v21
    v_permlane16_swap_b32 v32, v33
    v_mfma_f32_16x16x32_bf16 v[28:31], v[228:231], v[56:59], v[28:31]
    v_cvt_pk_bf16_f32 v18, v18, v22
    v_add_f32 v32, v32, v33
    v_mfma_f32_16x16x32_bf16 v[24:27], v[232:235], v[60:63], v[24:27]
    v_cvt_pk_bf16_f32 v19, v19, v23
    v_mul_f32 v32, 0x3ae38e39, v32
    v_mfma_f32_16x16x32_bf16 v[28:31], v[236:239], v[60:63], v[28:31]
    ds_write_b128 v72, v[16:19] offset:13056
    s_waitcnt lgkmcnt(1)
    v_mfma_f32_16x16x32_bf16 v[24:27], v[240:243], v[64:67], v[24:27]
    v_mfma_f32_16x16x32_bf16 v[28:31], v[244:247], v[64:67], v[28:31]
    v_mfma_f32_16x16x32_bf16 v[24:27], v[248:251], v[68:71], v[24:27]
    v_mfma_f32_16x16x32_bf16 v[28:31], v[252:255], v[68:71], v[28:31]
    s_mov_b32 s13, 0
    s_setprio 2
    s_add_u32 s66, s55, 1
    v_mov_b32 v99, s66
    ds_write_b32 v102, v99 offset:28
    s_nop 1
    ds_bpermute_b32 v74, v73, v26
    v_add_u32 v34, 0x22680, v73
    s_waitcnt lgkmcnt(0)
    v_mul_f32 v74, 0xbae38e39, v74
    v_fma_f32 v24, v74, v104, v24
    v_fma_f32 v25, v74, v105, v25
    v_fma_f32 v26, v74, v106, v26
    v_fma_f32 v27, v74, v107, v27
    v_fma_f32 v28, v74, v108, v28
    v_fma_f32 v29, v74, v109, v29
    v_fma_f32 v30, v74, v110, v30
    v_fma_f32 v31, v74, v111, v31
    v_cvt_pk_bf16_f32 v24, v24, v28
    v_cvt_pk_bf16_f32 v25, v25, v29
    v_cvt_pk_bf16_f32 v26, v26, v30
    v_cvt_pk_bf16_f32 v27, v27, v31
    ds_write_b128 v72, v[24:27] offset:4352
    v_fma_f32 v32, -v74, v74, v32
    v_max_f32 v32, 0, v32
    v_add_f32 v32, 0x3727c5ac, v32
    v_rsq_f32 v32, v32
    s_mov_b64 exec, 0xffff
    ds_write_b32 v34, v32
    s_mov_b64 exec, -1
    s_waitcnt lgkmcnt(0)
    s_add_u32 s66, s55, 1
    v_mov_b32 v99, s66
    ds_write_b32 v102, v99 offset:44
    s_cmp_lg_u32 s55, 0
    s_nop 0
    s_cbranch_scc1 Lknf_137
    s_mov_b32 s67, 2
Lwf_138:
    ds_read_b128 v[40:43], v102 offset:128
    s_waitcnt lgkmcnt(0)
    v_min3_u32 v40, v40, v41, v42
    v_min_u32 v40, v40, v43
    s_nop 0
    v_readfirstlane_b32 s68, v40
    s_nop 1
    s_cmp_ge_u32 s68, s67
    s_nop 1
    s_cbranch_scc1 Lwfd_139
    s_sub_u32 s56, s56, 1
    s_cmp_eq_u32 s56, 0
    s_mov_b32 s69, 21
    s_cbranch_scc1 L_ABORT
    s_branch Lwf_138
Lwfd_139:
    v_and_b32 v44, 15, v103
    v_lshlrev_b32 v44, 4, v44
    v_add_u32 v45, 256, v44
    v_and_b32 v46, 16, v103
    s_cmp_eq_u32 s51, 0
    s_cselect_b32 s60, 0, 16
    v_and_b32 v46, s60, v46
    v_cmp_eq_u32 s[62:63], 0, v46
    s_nop 1
    v_cndmask_b32 v44, v44, v45, s[62:63]
    s_lshl_b32 s60, s51, 8
    s_add_u32 s60, s60, 21298944
    s_nop 0
Lini_140:
    buffer_load_dwordx4 v[40:43], v44, s[40:43], s60 offen sc1
    s_waitcnt vmcnt(0)
    v_xor_b32 v40, s58, v40
    v_xor_b32 v41, s59, v41
    v_xor_b32 v43, s58, v43
    v_or3_b32 v40, v40, v41, v43
    v_cmp_ne_u32 vcc, 0, v40
    s_nop 1
    s_cmp_eq_u64 vcc, 0
    s_nop 1
    s_cbranch_scc1 Linid_141
    s_sub_u32 s56, s56, 1
    s_cmp_eq_u32 s56, 0
    s_mov_b32 s69, 8
    s_cbranch_scc1 L_ABORT
    s_sleep 2
    s_branch Lini_140
Linid_141:
    v_cmp_ne_u32 vcc, s93, v42
    s_nop 1
    s_and_b64 vcc, vcc, s[62:63]
    s_cmp_eq_u64 vcc, 0
    s_cselect_b32 s85, 1, 0
Lknf_137:
L_M_EPI:
    s_setprio 2
    v_lshlrev_b32 v92, 4, v103
    v_add_u32 v92, s8, v92
    ds_read_b128 v[70:73], v92
    ds_read_b128 v[74:77], v92 offset:1024
    ds_read_b128 v[84:87], v92 offset:2048
    s_mul_i32 s83, s53, 0
    s_mul_i32 s60, s54, 77824
    s_add_u32 s83, s83, s60
    s_add_u32 s83, s83, s95
    s_add_u32 s67, s55, 1
Lwf_142:
    ds_read_b128 v[92:95], v102 offset:32
    s_waitcnt lgkmcnt(0)
    v_min3_u32 v92, v92, v93, v94
    v_min_u32 v92, v92, v95
    s_nop 0
    v_readfirstlane_b32 s68, v92
    s_nop 1
    s_cmp_ge_u32 s68, s67
    s_nop 1
    s_cbranch_scc1 Lwfd_143
    s_sub_u32 s56, s56, 1
    s_cmp_eq_u32 s56, 0
    s_mov_b32 s69, 4
    s_cbranch_scc1 L_ABORT
    s_branch Lwf_142
Lwfd_143:
    ds_read_b128 v[0:3], v70
    ds_read_b128 v[4:7], v70 offset:16
    ds_read_b32 v8, v71 offset:80
    ds_read_b128 v[12:15], v72 offset:864
    ds_read_b128 v[24:27], v72 offset:592
    ds_read_b128 v[36:39], v72 offset:320
    ds_read_b128 v[48:51], v72 offset:48
    ds_read_b128 v[16:19], v72 offset:880
    ds_read_b128 v[28:31], v72 offset:608
    ds_read_b128 v[40:43], v72 offset:336
    ds_read_b128 v[52:55], v72 offset:64
    ds_read_b32 v20, v73 offset:928
    ds_read_b32 v32, v73 offset:656
    ds_read_b32 v44, v73 offset:384
    ds_read_b32 v56, v73 offset:112
    ds_read_b32 v64, v76
    ds_read2_b32 v[60:61], v77 offset0:0 offset1:1
    ds_read2_b32 v[62:63], v77 offset0:2 offset1:3
    s_waitcnt lgkmcnt(11)
    v_dot2_f32_bf16 v65, v0, v12, 0
    v_dot2_f32_bf16 v66, v0, v24, 0
    v_dot2_f32_bf16 v67, v0, v36, 0
    v_dot2_f32_bf16 v68, v0, v48, 0
    v_dot2_f32_bf16 v65, v1, v13, v65
    v_dot2_f32_bf16 v66, v1, v25, v66
    v_dot2_f32_bf16 v67, v1, v37, v67
    v_dot2_f32_bf16 v68, v1, v49, v68
    v_dot2_f32_bf16 v65, v2, v14, v65
    v_dot2_f32_bf16 v66, v2, v26, v66
    v_dot2_f32_bf16 v67, v2, v38, v67
    v_dot2_f32_bf16 v68, v2, v50, v68
    v_dot2_f32_bf16 v65, v3, v15, v65
    v_dot2_f32_bf16 v66, v3, v27, v66
    v_dot2_f32_bf16 v67, v3, v39, v67
    v_dot2_f32_bf16 v68, v3, v51, v68
    s_waitcnt lgkmcnt(7)
    v_dot2_f32_bf16 v65, v4, v16, v65
    v_dot2_f32_bf16 v66, v4, v28, v66
    v_dot2_f32_bf16 v67, v4, v40, v67
    v_dot2_f32_bf16 v68, v4, v52, v68
    v_dot2_f32_bf16 v65, v5, v17, v65
    v_dot2_f32_bf16 v66, v5, v29, v66
    v_dot2_f32_bf16 v67, v5, v41, v67
    v_dot2_f32_bf16 v68, v5, v53, v68
    v_dot2_f32_bf16 v65, v6, v18, v65
    v_dot2_f32_bf16 v66, v6, v30, v66
    v_dot2_f32_bf16 v67, v6, v42, v67
    v_dot2_f32_bf16 v68, v6, v54, v68
    v_dot2_f32_bf16 v65, v7, v19, v65
    v_dot2_f32_bf16 v66, v7, v31, v66
    v_dot2_f32_bf16 v67, v7, v43, v67
    v_dot2_f32_bf16 v68, v7, v55, v68
    s_waitcnt lgkmcnt(3)
    v_dot2_f32_bf16 v65, v8, v20, v65
    v_dot2_f32_bf16 v66, v8, v32, v66
    v_dot2_f32_bf16 v67, v8, v44, v67
    v_dot2_f32_bf16 v68, v8, v56, v68
    s_waitcnt lgkmcnt(0)
    ds_read_b128 v[12:15], v74 offset:1936
    ds_read_b32 v16, v75 offset:2112
    ds_read_b128 v[18:21], v74 offset:1664
    ds_read_b32 v22, v75 offset:1840
    ds_read_b128 v[24:27], v74 offset:1392
    ds_read_b32 v28, v75 offset:1568
    ds_read_b128 v[30:33], v74 offset:1120
    ds_read_b32 v34, v75 offset:1296
    ds_read_b128 v[36:39], v74 offset:848
    ds_read_b32 v40, v75 offset:1024
    ds_read_b128 v[42:45], v74 offset:576
    ds_read_b32 v46, v75 offset:752
    ds_read_b128 v[48:51], v74 offset:304
    ds_read_b32 v52, v75 offset:480
    ds_read_b128 v[54:57], v74 offset:32
    ds_read_b32 v58, v75 offset:208
    v_mul_f32 v64, 0x3eae1a93, v64
    v_mul_f32 v65, v65, v63
    v_mul_f32 v66, v66, v62
    v_mul_f32 v67, v67, v61
    v_mul_f32 v68, v68, v60
    v_mul_f32 v65, v65, v64
    v_mul_f32 v66, v66, v64
    v_mul_f32 v67, v67, v64
    v_mul_f32 v68, v68, v64
    s_or_b32 s60, s51, s49
    s_cmp_lg_u32 s60, 0
    s_nop 0
    s_cbranch_scc1 Lnomask_144
    v_lshlrev_b32 v76, 2, v87
    v_mov_b32 v78, 0xf149f2ca
    v_add_u32 v77, 0, v76
    v_cmp_lt_u32 vcc, v86, v77
    s_nop 1
    v_cndmask_b32 v65, v65, v78, vcc
    v_add_u32 v77, 1, v76
    v_cmp_lt_u32 vcc, v86, v77
    s_nop 1
    v_cndmask_b32 v66, v66, v78, vcc
    v_add_u32 v77, 2, v76
    v_cmp_lt_u32 vcc, v86, v77
    s_nop 1
    v_cndmask_b32 v67, v67, v78, vcc
    v_add_u32 v77, 3, v76
    v_cmp_lt_u32 vcc, v86, v77
    s_nop 1
    v_cndmask_b32 v68, v68, v78, vcc
    s_nop 2
Lnomask_144:
    v_max3_f32 v76, v65, v66, v67
    v_max_f32 v76, v76, v68
    v_cmp_eq_u32 vcc, 1, v87
    s_nop 0
    v_max_f32_dpp v77, v76, v76 quad_perm:[1,0,3,2] row_mask:0xf bank_mask:0xf
    v_sub_f32 v65, v65, v77
    v_sub_f32 v66, v66, v77
    v_sub_f32 v67, v67, v77
    v_sub_f32 v68, v68, v77
    v_exp_f32 v65, v65
    v_exp_f32 v66, v66
    v_exp_f32 v67, v67
    v_exp_f32 v68, v68
    v_add_f32 v76, v65, v66
    v_add_f32 v77, v67, v68
    v_add_f32 v76, v76, v77
    v_mul_f32 v65, v65, v63
    v_mul_f32 v66, v66, v62
    v_mul_f32 v67, v67, v61
    v_mul_f32 v68, v68, v60
    v_add_f32_dpp v77, v76, v76 quad_perm:[1,0,3,2] row_mask:0xf bank_mask:0xf
    v_rcp_f32 v77, v77
    s_nop 0
    v_mul_f32 v65, v65, v77
    v_mul_f32 v66, v66, v77
    v_mul_f32 v67, v67, v77
    v_mul_f32 v68, v68, v77
    v_cvt_pk_bf16_f32 v76, v65, v66
    v_cvt_pk_bf16_f32 v77, v67, v68
    s_nop 0
    v_mov_b32_dpp v78, v76 quad_perm:[1,0,3,2] row_mask:0xf bank_mask:0xf
    v_mov_b32_dpp v79, v77 quad_perm:[1,0,3,2] row_mask:0xf bank_mask:0xf
    v_cndmask_b32 v60, v76, v78, vcc
    v_cndmask_b32 v61, v77, v79, vcc
    v_cndmask_b32 v62, v78, v76, vcc
    v_cndmask_b32 v63, v79, v77, vcc
    v_and_b32 v64, 0xffff, v60
    v_lshlrev_b32 v65, 16, v60
    v_lshrrev_b32 v66, 16, v60
    v_and_b32 v67, 0xffff0000, v60
    v_and_b32 v68, 0xffff, v61
    v_lshlrev_b32 v69, 16, v61
    v_lshrrev_b32 v70, 16, v61
    v_and_b32 v71, 0xffff0000, v61
    v_and_b32 v72, 0xffff, v62
    v_lshlrev_b32 v73, 16, v62
    v_lshrrev_b32 v74, 16, v62
    v_and_b32 v75, 0xffff0000, v62
    v_and_b32 v76, 0xffff, v63
    v_lshlrev_b32 v77, 16, v63
    v_lshrrev_b32 v78, 16, v63
    v_and_b32 v79, 0xffff0000, v63
    s_waitcnt lgkmcnt(14)
    v_dot2_f32_bf16 v0, v12, v64, 0
    v_dot2_f32_bf16 v1, v12, v65, 0
    v_dot2_f32_bf16 v2, v13, v64, 0
    v_dot2_f32_bf16 v3, v13, v65, 0
    v_dot2_f32_bf16 v4, v14, v64, 0
    v_dot2_f32_bf16 v5, v14, v65, 0
    v_dot2_f32_bf16 v6, v15, v64, 0
    v_dot2_f32_bf16 v7, v15, v65, 0
    v_dot2_f32_bf16 v8, v16, v64, 0
    v_dot2_f32_bf16 v9, v16, v65, 0
    s_waitcnt lgkmcnt(12)
    v_dot2_f32_bf16 v0, v18, v66, v0
    v_dot2_f32_bf16 v1, v18, v67, v1
    v_dot2_f32_bf16 v2, v19, v66, v2
    v_dot2_f32_bf16 v3, v19, v67, v3
    v_dot2_f32_bf16 v4, v20, v66, v4
    v_dot2_f32_bf16 v5, v20, v67, v5
    v_dot2_f32_bf16 v6, v21, v66, v6
    v_dot2_f32_bf16 v7, v21, v67, v7
    v_dot2_f32_bf16 v8, v22, v66, v8
    v_dot2_f32_bf16 v9, v22, v67, v9
    s_waitcnt lgkmcnt(10)
    v_dot2_f32_bf16 v0, v24, v68, v0
    v_dot2_f32_bf16 v1, v24, v69, v1
    v_dot2_f32_bf16 v2, v25, v68, v2
    v_dot2_f32_bf16 v3, v25, v69, v3
    v_dot2_f32_bf16 v4, v26, v68, v4
    v_dot2_f32_bf16 v5, v26, v69, v5
    v_dot2_f32_bf16 v6, v27, v68, v6
    v_dot2_f32_bf16 v7, v27, v69, v7
    v_dot2_f32_bf16 v8, v28, v68, v8
    v_dot2_f32_bf16 v9, v28, v69, v9
    s_waitcnt lgkmcnt(8)
    v_dot2_f32_bf16 v0, v30, v70, v0
    v_dot2_f32_bf16 v1, v30, v71, v1
    v_dot2_f32_bf16 v2, v31, v70, v2
    v_dot2_f32_bf16 v3, v31, v71, v3
    v_dot2_f32_bf16 v4, v32, v70, v4
    v_dot2_f32_bf16 v5, v32, v71, v5
    v_dot2_f32_bf16 v6, v33, v70, v6
    v_dot2_f32_bf16 v7, v33, v71, v7
    v_dot2_f32_bf16 v8, v34, v70, v8
    v_dot2_f32_bf16 v9, v34, v71, v9
    s_waitcnt lgkmcnt(6)
    v_dot2_f32_bf16 v0, v36, v72, v0
    v_dot2_f32_bf16 v1, v36, v73, v1
    v_dot2_f32_bf16 v2, v37, v72, v2
    v_dot2_f32_bf16 v3, v37, v73, v3
    v_dot2_f32_bf16 v4, v38, v72, v4
    v_dot2_f32_bf16 v5, v38, v73, v5
    v_dot2_f32_bf16 v6, v39, v72, v6
    v_dot2_f32_bf16 v7, v39, v73, v7
    v_dot2_f32_bf16 v8, v40, v72, v8
    v_dot2_f32_bf16 v9, v40, v73, v9
    s_waitcnt lgkmcnt(4)
    v_dot2_f32_bf16 v0, v42, v74, v0
    v_dot2_f32_bf16 v1, v42, v75, v1
    v_dot2_f32_bf16 v2, v43, v74, v2
    v_dot2_f32_bf16 v3, v43, v75, v3
    v_dot2_f32_bf16 v4, v44, v74, v4
    v_dot2_f32_bf16 v5, v44, v75, v5
    v_dot2_f32_bf16 v6, v45, v74, v6
    v_dot2_f32_bf16 v7, v45, v75, v7
    v_dot2_f32_bf16 v8, v46, v74, v8
    v_dot2_f32_bf16 v9, v46, v75, v9
    s_waitcnt lgkmcnt(2)
    v_dot2_f32_bf16 v0, v48, v76, v0
    v_dot2_f32_bf16 v1, v48, v77, v1
    v_dot2_f32_bf16 v2, v49, v76, v2
    v_dot2_f32_bf16 v3, v49, v77, v3
    v_dot2_f32_bf16 v4, v50, v76, v4
    v_dot2_f32_bf16 v5, v50, v77, v5
    v_dot2_f32_bf16 v6, v51, v76, v6
    v_dot2_f32_bf16 v7, v51, v77, v7
    v_dot2_f32_bf16 v8, v52, v76, v8
    v_dot2_f32_bf16 v9, v52, v77, v9
    s_waitcnt lgkmcnt(0)
    v_dot2_f32_bf16 v0, v54, v78, v0
    v_dot2_f32_bf16 v1, v54, v79, v1
    v_dot2_f32_bf16 v2, v55, v78, v2
    v_dot2_f32_bf16 v3, v55, v79, v3
    v_dot2_f32_bf16 v4, v56, v78, v4
    v_dot2_f32_bf16 v5, v56, v79, v5
    v_dot2_f32_bf16 v6, v57, v78, v6
    v_dot2_f32_bf16 v7, v57, v79, v7
    v_dot2_f32_bf16 v8, v58, v78, v8
    v_dot2_f32_bf16 v9, v58, v79, v9
    v_cvt_pk_bf16_f32 v12, v0, v1
    v_cvt_pk_bf16_f32 v13, v2, v3
    v_cvt_pk_bf16_f32 v14, v4, v5
    v_cvt_pk_bf16_f32 v15, v6, v7
    v_cvt_pk_bf16_f32 v16, v8, v9
    s_mov_b32 s62, 0x55555555
    s_mov_b32 s63, 0x55555555
    s_cmp_eq_u32 s85, 0
    s_cbranch_scc1 Lslow_145
    buffer_store_dwordx4 v[12:15], v84, s[40:43], s83 offen
    s_mov_b64 exec, s[62:63]
    buffer_store_dword v16, v85, s[40:43], s83 offen
    s_mov_b64 exec, -1
    s_lshl_b32 s68, s49, 2
    v_add_u32 v20, s68, v102
    s_add_u32 s68, s55, 1
    v_mov_b32 v21, s68
    ds_write_b32 v20, v21 offset:48
    s_mov_b32 s7, 1
    s_cmp_eq_u32 s54, 0
    s_cbranch_scc1 Ldefer_147
    s_mov_b32 s7, 0
    s_lshl_b32 s60, s54, 9
    s_add_u32 s60, s60, s12
    s_lshl_b32 s61, s52, 3
    s_add_u32 s60, s60, s61
    s_add_u32 s61, s58, s53
    s_add_u32 s61, s61, 1
    v_mov_b32 v24, s61
    v_mov_b32 v25, s59
    v_mov_b32 v26, 0
    s_mov_b64 exec, 1
    s_waitcnt vmcnt(0)
    buffer_store_dwordx2 v[24:25], v26, s[40:43], s60 offen
    s_mov_b64 exec, -1
Ldefer_147:
    s_branch Lmend_146
Lslow_145:
    buffer_store_dwordx4 v[12:15], v84, s[40:43], s83 offen sc1
    s_mov_b64 exec, s[62:63]
    buffer_store_dword v16, v85, s[40:43], s83 offen sc1
    s_mov_b64 exec, -1
    s_lshl_b32 s68, s49, 2
    v_add_u32 v20, s68, v102
    s_add_u32 s68, s55, 1
    v_mov_b32 v21, s68
    ds_write_b32 v20, v21 offset:48
    s_mov_b32 s7, 1
    s_cmp_eq_u32 s54, 0
    s_cbranch_scc1 Ldefer_148
    s_mov_b32 s7, 0
    s_lshl_b32 s60, s54, 9
    s_add_u32 s60, s60, s12
    s_lshl_b32 s61, s52, 3
    s_add_u32 s60, s60, s61
    s_add_u32 s61, s58, s53
    s_add_u32 s61, s61, 1
    v_mov_b32 v24, s61
    v_mov_b32 v25, s59
    v_mov_b32 v26, 0
    s_mov_b64 exec, 1
    s_waitcnt vmcnt(0)
    buffer_store_dwordx2 v[24:25], v26, s[40:43], s60 offen sc1
    s_mov_b64 exec, -1
Ldefer_148:
Lmend_146:
    s_add_u32 s54, s54, 1
    s_cmp_lt_u32 s54, 2
    s_cbranch_scc1 L_M_TASK
    s_mov_b32 s54, 1
    s_branch L_BPHASE
L_BPHASE:
    s_mul_i32 s83, s53, 0
    s_mul_i32 s60, s54, 77824
    s_add_u32 s83, s83, s60
    s_add_u32 s83, s83, s95
    v_lshlrev_b32 v100, 4, v103
    v_add_u32 v100, s8, v100
    ds_read_b128 v[96:99], v100 offset:3072
    s_waitcnt lgkmcnt(0)
    v_and_b32 v50, 15, v103
    v_lshlrev_b32 v50, 3, v50
    s_lshl_b32 s60, s54, 9
    s_add_u32 s60, s60, s12
    s_add_u32 s61, s58, s53
    s_add_u32 s61, s61, 1
    s_setprio 0
Lpoll_149:
    buffer_load_dwordx2 v[48:49], v50, s[40:43], s60 offen sc1
    s_waitcnt vmcnt(0)
    s_cmp_eq_u32 s15, 0
    s_cbranch_scc1 Lwop_151
    s_lshl_b32 s68, s49, 2
    v_add_u32 v60, s68, v102
    s_add_u32 s68, s53, 1
    v_mov_b32 v61, s68
    ds_write_b32 v60, v61 offset:64
    s_mov_b32 s15, 0
    s_nop 0
Lwop_151:
    v_subrev_u32 v48, s61, v48
    v_xor_b32 v49, s59, v49
    v_lshrrev_b32 v48, 3, v48
    v_or_b32 v48, v48, v49
    v_cmp_ne_u32 vcc, 0, v48
    s_nop 1
    s_cmp_eq_u64 vcc, 0
    s_nop 1
    s_cbranch_scc1 Lpolld_150
    s_sub_u32 s56, s56, 1
    s_cmp_eq_u32 s56, 0
    s_mov_b32 s69, 13
    s_cbranch_scc1 L_ABORT
    s_branch Lpoll_149
Lpolld_150:
    s_setprio 2
    s_add_u32 s62, s83, 948992
    buffer_load_dwordx4 v[0:3], v96, s[88:91], s62 offen offset:0 sc1
    buffer_load_dwordx4 v[4:7], v96, s[88:91], s62 offen offset:1024 sc1
    buffer_load_dwordx4 v[8:11], v96, s[88:91], s62 offen offset:2048 sc1
    buffer_load_dwordx4 v[12:15], v96, s[88:91], s62 offen offset:3072 sc1
    s_add_u32 s62, s83, 953088
    buffer_load_dwordx4 v[16:19], v96, s[88:91], s62 offen offset:0 sc1
    buffer_load_dwordx4 v[20:23], v96, s[88:91], s62 offen offset:1024 sc1
    buffer_load_dwordx4 v[24:27], v96, s[88:91], s62 offen offset:2048 sc1
    buffer_load_dwordx4 v[28:31], v96, s[88:91], s62 offen offset:3072 sc1
    s_add_u32 s62, s83, 957184
    buffer_load_dwordx4 v[32:35], v96, s[88:91], s62 offen offset:0 sc1
    buffer_load_dwordx4 v[36:39], v96, s[88:91], s62 offen offset:1024 sc1
    buffer_load_dwordx4 v[40:43], v96, s[88:91], s62 offen offset:2048 sc1
    buffer_load_dwordx4 v[44:47], v96, s[88:91], s62 offen offset:3072 sc1
    s_add_u32 s67, s53, 1
Lwf_152:
    ds_read_b128 v[60:63], v102 offset:64
    s_waitcnt lgkmcnt(0)
    v_min3_u32 v60, v60, v61, v62
    v_min_u32 v60, v60, v63
    s_nop 0
    v_readfirstlane_b32 s68, v60
    s_nop 1
    s_cmp_ge_u32 s68, s67
    s_nop 1
    s_cbranch_scc1 Lwfd_153
    s_sub_u32 s56, s56, 1
    s_cmp_eq_u32 s56, 0
    s_mov_b32 s69, 10
    s_cbranch_scc1 L_ABORT
    s_branch Lwf_152
Lwfd_153:
    ds_read_b128 v[60:63], v96 offset:0
    ds_read_b128 v[64:67], v96 offset:1024
    ds_read_b128 v[68:71], v97 offset:0
    ds_read_b128 v[72:75], v96 offset:2304
    ds_read_b128 v[76:79], v96 offset:3328
    ds_read_b128 v[80:83], v97 offset:2304
    ds_read_b128 v[84:87], v96 offset:4608
    ds_read_b128 v[88:91], v96 offset:5632
    ds_read_b128 v[92:95], v97 offset:4608
    s_waitcnt vmcnt(11) lgkmcnt(6)
    v_mfma_f32_16x16x32_bf16 v[48:51], v[60:63], v[0:3], 0
    ds_read_b128 v[60:63], v96 offset:6912
    v_mfma_f32_16x16x32_bf16 v[52:55], v[64:67], v[0:3], 0
    ds_read_b128 v[64:67], v96 offset:7936
    v_mfma_f32_16x16x32_bf16 v[56:59], v[68:71], v[0:3], 0
    ds_read_b128 v[68:71], v97 offset:6912
    s_add_u32 s62, s83, 961280
    buffer_load_dwordx4 v[0:3], v96, s[88:91], s62 offen offset:0 sc1
    s_waitcnt vmcnt(11) lgkmcnt(6)
    v_mfma_f32_16x16x32_bf16 v[48:51], v[72:75], v[4:7], v[48:51]
    ds_read_b128 v[72:75], v96 offset:9216
    v_mfma_f32_16x16x32_bf16 v[52:55], v[76:79], v[4:7], v[52:55]
    ds_read_b128 v[76:79], v96 offset:10240
    v_mfma_f32_16x16x32_bf16 v[56:59], v[80:83], v[4:7], v[56:59]
    ds_read_b128 v[80:83], v97 offset:9216
    buffer_load_dwordx4 v[4:7], v96, s[88:91], s62 offen offset:1024 sc1
    s_waitcnt vmcnt(11) lgkmcnt(6)
    v_mfma_f32_16x16x32_bf16 v[48:51], v[84:87], v[8:11], v[48:51]
    ds_read_b128 v[84:87], v96 offset:11520
    v_mfma_f32_16x16x32_bf16 v[52:55], v[88:91], v[8:11], v[52:55]
    ds_read_b128 v[88:91], v96 offset:12544
    v_mfma_f32_16x16x32_bf16 v[56:59], v[92:95], v[8:11], v[56:59]
    ds_read_b128 v[92:95], v97 offset:11520
    buffer_load_dwordx4 v[8:11], v96, s[88:91], s62 offen offset:2048 sc1
    s_waitcnt vmcnt(11) lgkmcnt(6)
    v_mfma_f32_16x16x32_bf16 v[48:51], v[60:63], v[12:15], v[48:51]
    ds_read_b128 v[60:63], v96 offset:13824
    v_mfma_f32_16x16x32_bf16 v[52:55], v[64:67], v[12:15], v[52:55]
    ds_read_b128 v[64:67], v96 offset:14848
    v_mfma_f32_16x16x32_bf16 v[56:59], v[68:71], v[12:15], v[56:59]
    ds_read_b128 v[68:71], v97 offset:13824
    buffer_load_dwordx4 v[12:15], v96, s[88:91], s62 offen offset:3072 sc1
    s_waitcnt vmcnt(11) lgkmcnt(6)
    v_mfma_f32_16x16x32_bf16 v[48:51], v[72:75], v[16:19], v[48:51]
    ds_read_b128 v[72:75], v96 offset:16128
    v_mfma_f32_16x16x32_bf16 v[52:55], v[76:79], v[16:19], v[52:55]
    ds_read_b128 v[76:79], v96 offset:17152
    v_mfma_f32_16x16x32_bf16 v[56:59], v[80:83], v[16:19], v[56:59]
    ds_read_b128 v[80:83], v97 offset:16128
    s_add_u32 s63, s83, 16384
    buffer_load_dwordx2 v[16:17], v98, s[40:43], s63 offen offset:0 sc1
    buffer_load_dwordx2 v[18:19], v98, s[40:43], s63 offen offset:128 sc1
    s_waitcnt vmcnt(12) lgkmcnt(6)
    v_mfma_f32_16x16x32_bf16 v[48:51], v[84:87], v[20:23], v[48:51]
    ds_read_b128 v[84:87], v96 offset:18432
    v_mfma_f32_16x16x32_bf16 v[52:55], v[88:91], v[20:23], v[52:55]
    ds_read_b128 v[88:91], v96 offset:19456
    v_mfma_f32_16x16x32_bf16 v[56:59], v[92:95], v[20:23], v[56:59]
    ds_read_b128 v[92:95], v97 offset:18432
    s_add_u32 s63, s83, 16384
    buffer_load_dwordx2 v[20:21], v98, s[40:43], s63 offen offset:1024 sc1
    buffer_load_dwordx2 v[22:23], v98, s[40:43], s63 offen offset:1152 sc1
    s_waitcnt vmcnt(13) lgkmcnt(6)
    v_mfma_f32_16x16x32_bf16 v[48:51], v[60:63], v[24:27], v[48:51]
    ds_read_b128 v[60:63], v96 offset:20736
    v_mfma_f32_16x16x32_bf16 v[52:55], v[64:67], v[24:27], v[52:55]
    ds_read_b128 v[64:67], v96 offset:21760
    v_mfma_f32_16x16x32_bf16 v[56:59], v[68:71], v[24:27], v[56:59]
    ds_read_b128 v[68:71], v97 offset:20736
    s_waitcnt vmcnt(12) lgkmcnt(6)
    v_mfma_f32_16x16x32_bf16 v[48:51], v[72:75], v[28:31], v[48:51]
    ds_read_b128 v[72:75], v96 offset:23040
    v_mfma_f32_16x16x32_bf16 v[52:55], v[76:79], v[28:31], v[52:55]
    ds_read_b128 v[76:79], v96 offset:24064
    v_mfma_f32_16x16x32_bf16 v[56:59], v[80:83], v[28:31], v[56:59]
    ds_read_b128 v[80:83], v97 offset:23040
    s_waitcnt vmcnt(11) lgkmcnt(6)
    v_mfma_f32_16x16x32_bf16 v[48:51], v[84:87], v[32:35], v[48:51]
    ds_read_b128 v[84:87], v96 offset:25344
    v_mfma_f32_16x16x32_bf16 v[52:55], v[88:91], v[32:35], v[52:55]
    ds_read_b128 v[88:91], v96 offset:26368
    v_mfma_f32_16x16x32_bf16 v[56:59], v[92:95], v[32:35], v[56:59]
    ds_read_b128 v[92:95], v97 offset:25344
    s_waitcnt vmcnt(10) lgkmcnt(6)
    v_mfma_f32_16x16x32_bf16 v[48:51], v[60:63], v[36:39], v[48:51]
    ds_read_b128 v[60:63], v96 offset:27648
    v_mfma_f32_16x16x32_bf16 v[52:55], v[64:67], v[36:39], v[52:55]
    ds_read_b128 v[64:67], v96 offset:28672
    v_mfma_f32_16x16x32_bf16 v[56:59], v[68:71], v[36:39], v[56:59]
    ds_read_b128 v[68:71], v97 offset:27648
    ds_read_b128 v[32:35], v100 offset:4096
    s_waitcnt vmcnt(9) lgkmcnt(6)
    v_mfma_f32_16x16x32_bf16 v[48:51], v[72:75], v[40:43], v[48:51]
    ds_read_b128 v[72:75], v96 offset:29952
    v_mfma_f32_16x16x32_bf16 v[52:55], v[76:79], v[40:43], v[52:55]
    ds_read_b128 v[76:79], v96 offset:30976
    v_mfma_f32_16x16x32_bf16 v[56:59], v[80:83], v[40:43], v[56:59]
    ds_read_b128 v[80:83], v97 offset:29952
    s_add_u32 s84, s83, 9437184
    s_mul_i32 s64, s54, 1152
    s_waitcnt lgkmcnt(3)
    s_cmp_eq_u32 s53, 0
    s_cbranch_scc1 Lres0_154
    buffer_load_dwordx4 v[24:27], v32, s[40:43], s84 offen sc1
    buffer_load_dwordx2 v[28:29], v33, s[40:43], s84 offen sc1
    s_branch Lres1_155
Lres0_154:
    buffer_load_dwordx4 v[24:27], v34, s[24:27], s64 offen
    buffer_load_dwordx2 v[28:29], v35, s[24:27], s64 offen
Lres1_155:
    s_waitcnt vmcnt(10) lgkmcnt(6)
    v_mfma_f32_16x16x32_bf16 v[48:51], v[84:87], v[44:47], v[48:51]
    ds_read_b128 v[84:87], v96 offset:32256
    v_mfma_f32_16x16x32_bf16 v[52:55], v[88:91], v[44:47], v[52:55]
    ds_read_b128 v[88:91], v96 offset:33280
    v_mfma_f32_16x16x32_bf16 v[56:59], v[92:95], v[44:47], v[56:59]
    ds_read_b128 v[92:95], v97 offset:32256
    s_waitcnt vmcnt(9) lgkmcnt(6)
    v_mfma_f32_16x16x32_bf16 v[48:51], v[60:63], v[0:3], v[48:51]
    ds_read_b128 v[60:63], v96 offset:34560
    v_mfma_f32_16x16x32_bf16 v[52:55], v[64:67], v[0:3], v[52:55]
    ds_read_b128 v[64:67], v96 offset:35584
    v_mfma_f32_16x16x32_bf16 v[56:59], v[68:71], v[0:3], v[56:59]
    ds_read_b128 v[68:71], v97 offset:34560
    s_waitcnt vmcnt(8) lgkmcnt(6)
    v_mfma_f32_16x16x32_bf16 v[48:51], v[72:75], v[4:7], v[48:51]
    ds_read_b128 v[72:75], v96 offset:36864
    v_mfma_f32_16x16x32_bf16 v[52:55], v[76:79], v[4:7], v[52:55]
    ds_read_b128 v[76:79], v96 offset:37888
    v_mfma_f32_16x16x32_bf16 v[56:59], v[80:83], v[4:7], v[56:59]
    ds_read_b128 v[80:83], v97 offset:36864
    s_waitcnt vmcnt(7) lgkmcnt(6)
    v_mfma_f32_16x16x32_bf16 v[48:51], v[84:87], v[8:11], v[48:51]
    ds_read_b128 v[84:87], v96 offset:39168
    v_mfma_f32_16x16x32_bf16 v[52:55], v[88:91], v[8:11], v[52:55]
    ds_read_b128 v[88:91], v96 offset:40192
    v_mfma_f32_16x16x32_bf16 v[56:59], v[92:95], v[8:11], v[56:59]
    ds_read_b128 v[92:95], v97 offset:39168
    s_waitcnt vmcnt(6) lgkmcnt(6)
    v_mfma_f32_16x16x32_bf16 v[48:51], v[60:63], v[12:15], v[48:51]
    v_mfma_f32_16x16x32_bf16 v[52:55], v[64:67], v[12:15], v[52:55]
    v_mfma_f32_16x16x32_bf16 v[56:59], v[68:71], v[12:15], v[56:59]
    s_waitcnt vmcnt(4) lgkmcnt(3)
    v_mfma_f32_16x16x32_bf16 v[48:51], v[72:75], v[16:19], v[48:51]
    v_mfma_f32_16x16x32_bf16 v[52:55], v[76:79], v[16:19], v[52:55]
    v_mfma_f32_16x16x32_bf16 v[56:59], v[80:83], v[16:19], v[56:59]
    s_waitcnt vmcnt(2) lgkmcnt(0)
    v_mfma_f32_16x16x32_bf16 v[48:51], v[84:87], v[20:23], v[48:51]
    v_mfma_f32_16x16x32_bf16 v[52:55], v[88:91], v[20:23], v[52:55]
    v_mfma_f32_16x16x32_bf16 v[56:59], v[92:95], v[20:23], v[56:59]
    s_nop 6
    v_cvt_pk_bf16_f32 v0, v48, v52
    v_cvt_pk_bf16_f32 v1, v49, v53
    v_cvt_pk_bf16_f32 v2, v50, v54
    v_cvt_pk_bf16_f32 v3, v51, v55
    v_cvt_pk_bf16_f32 v4, v56, v57
    v_cvt_pk_bf16_f32 v5, v58, v59
    s_waitcnt vmcnt(0)
    v_lshlrev_b32 v60, 16, v0
    v_and_b32 v61, 0xffff0000, v0
    v_lshlrev_b32 v72, 16, v24
    v_and_b32 v73, 0xffff0000, v24
    v_lshlrev_b32 v62, 16, v1
    v_and_b32 v63, 0xffff0000, v1
    v_lshlrev_b32 v74, 16, v25
    v_and_b32 v75, 0xffff0000, v25
    v_lshlrev_b32 v64, 16, v2
    v_and_b32 v65, 0xffff0000, v2
    v_lshlrev_b32 v76, 16, v26
    v_and_b32 v77, 0xffff0000, v26
    v_lshlrev_b32 v66, 16, v3
    v_and_b32 v67, 0xffff0000, v3
    v_lshlrev_b32 v78, 16, v27
    v_and_b32 v79, 0xffff0000, v27
    v_lshlrev_b32 v68, 16, v4
    v_and_b32 v69, 0xffff0000, v4
    v_lshlrev_b32 v80, 16, v28
    v_and_b32 v81, 0xffff0000, v28
    v_lshlrev_b32 v70, 16, v5
    v_and_b32 v71, 0xffff0000, v5
    v_lshlrev_b32 v82, 16, v29
    v_and_b32 v83, 0xffff0000, v29
    v_add_f32 v60, v60, v72
    v_add_f32 v61, v61, v73
    v_add_f32 v62, v62, v74
    v_add_f32 v63, v63, v75
    v_add_f32 v64, v64, v76
    v_add_f32 v65, v65, v77
    v_add_f32 v66, v66, v78
    v_add_f32 v67, v67, v79
    v_add_f32 v68, v68, v80
    v_add_f32 v69, v69, v81
    v_add_f32 v70, v70, v82
    v_add_f32 v71, v71, v83
    v_cvt_pk_bf16_f32 v0, v60, v61
    v_cvt_pk_bf16_f32 v1, v62, v63
    v_cvt_pk_bf16_f32 v2, v64, v65
    v_cvt_pk_bf16_f32 v3, v66, v67
    v_cvt_pk_bf16_f32 v4, v68, v69
    v_cvt_pk_bf16_f32 v5, v70, v71
    s_cmp_eq_u32 s53, 3
    s_nop 1
    s_cbranch_scc1 Lst0_156
    s_cmp_eq_u32 s85, 0
    s_cbranch_scc1 Lslow_158
    buffer_store_dwordx4 v[0:3], v32, s[40:43], s84 offen
    s_mov_b64 exec, 0xffff
    buffer_store_dwordx2 v[4:5], v33, s[40:43], s84 offen
    s_mov_b64 exec, -1
    v_dot2_f32_bf16 v8, v0, v0, 0
    v_dot2_f32_bf16 v8, v1, v1, v8
    v_dot2_f32_bf16 v8, v2, v2, v8
    v_dot2_f32_bf16 v8, v3, v3, v8
    v_dot2_f32_bf16 v10, v4, v4, 0
    v_dot2_f32_bf16 v10, v5, v5, v10
    v_lshrrev_b32 v11, 1, v33
    v_mov_b32 v9, v8
    s_nop 1
    v_permlane32_swap_b32 v8, v9
    v_add_f32 v8, v8, v9
    v_mov_b32 v9, v8
    s_nop 1
    v_permlane16_swap_b32 v8, v9
    v_add_f32 v8, v8, v9
    v_add_f32 v8, v8, v10
    s_add_u32 s62, s84, 10240
    s_mov_b64 exec, 0xffff
    buffer_store_dword v8, v11, s[40:43], s62 offen
    s_mov_b64 exec, -1
    s_lshl_b32 s60, s54, 9
    s_add_u32 s60, s60, s12
    s_lshl_b32 s61, s52, 3
    s_add_u32 s60, s60, s61
    s_add_u32 s60, s60, 1024
    s_add_u32 s61, s58, s53
    s_add_u32 s61, s61, 1
    v_mov_b32 v44, s61
    v_mov_b32 v45, s59
    v_mov_b32 v46, 0
    s_mov_b64 exec, 1
    s_waitcnt vmcnt(0)
    buffer_store_dwordx2 v[44:45], v46, s[40:43], s60 offen
    s_mov_b64 exec, -1
    s_branch Lmend_159
Lslow_158:
    buffer_store_dwordx4 v[0:3], v32, s[40:43], s84 offen sc1
    s_mov_b64 exec, 0xffff
    buffer_store_dwordx2 v[4:5], v33, s[40:43], s84 offen sc1
    s_mov_b64 exec, -1
    v_dot2_f32_bf16 v8, v0, v0, 0
    v_dot2_f32_bf16 v8, v1, v1, v8
    v_dot2_f32_bf16 v8, v2, v2, v8
    v_dot2_f32_bf16 v8, v3, v3, v8
    v_dot2_f32_bf16 v10, v4, v4, 0
    v_dot2_f32_bf16 v10, v5, v5, v10
    v_lshrrev_b32 v11, 1, v33
    v_mov_b32 v9, v8
    s_nop 1
    v_permlane32_swap_b32 v8, v9
    v_add_f32 v8, v8, v9
    v_mov_b32 v9, v8
    s_nop 1
    v_permlane16_swap_b32 v8, v9
    v_add_f32 v8, v8, v9
    v_add_f32 v8, v8, v10
    s_add_u32 s62, s84, 10240
    s_mov_b64 exec, 0xffff
    buffer_store_dword v8, v11, s[40:43], s62 offen sc1
    s_mov_b64 exec, -1
    s_lshl_b32 s60, s54, 9
    s_add_u32 s60, s60, s12
    s_lshl_b32 s61, s52, 3
    s_add_u32 s60, s60, s61
    s_add_u32 s60, s60, 1024
    s_add_u32 s61, s58, s53
    s_add_u32 s61, s61, 1
    v_mov_b32 v44, s61
    v_mov_b32 v45, s59
    v_mov_b32 v46, 0
    s_mov_b64 exec, 1
    s_waitcnt vmcnt(0)
    buffer_store_dwordx2 v[44:45], v46, s[40:43], s60 offen sc1
    s_mov_b64 exec, -1
Lmend_159:
    s_branch Lst1_157
Lst0_156:
    buffer_store_dwordx4 v[0:3], v34, s[36:39], s64 offen
    s_mov_b64 exec, 0xffff
    buffer_store_dwordx2 v[4:5], v35, s[36:39], s64 offen
    s_mov_b64 exec, -1
Lst1_157:
    s_lshl_b32 s60, s54, 4
    s_lshl_b32 s61, s49, 2
    s_sub_u32 s60, s61, s60
    v_add_u32 v60, s60, v102
    s_add_u32 s60, s53, 1
    v_mov_b32 v61, s60
    ds_write_b32 v60, v61 offset:96
    s_add_u32 s53, s53, 1
    s_cmp_ge_u32 s53, 4
    s_cbranch_scc1 L_END
L_STAGE:
    s_cmp_eq_u32 s14, 0
    s_cbranch_scc1 Lnocs_160
    s_waitcnt vmcnt(0)
    v_mov_b32 v8, 0x3f803f80
    v_mov_b32 v9, 0x3f803f80
    v_mov_b32 v10, 0x3f803f80
    v_mov_b32 v11, 0x3f803f80
    s_nop 1
    v_mfma_f32_16x16x32_bf16 v[104:107], v[112:115], v[8:11], 0
    v_mfma_f32_16x16x32_bf16 v[108:111], v[116:119], v[8:11], 0
    v_mfma_f32_16x16x32_bf16 v[104:107], v[120:123], v[8:11], v[104:107]
    v_mfma_f32_16x16x32_bf16 v[108:111], v[124:127], v[8:11], v[108:111]
    v_mfma_f32_16x16x32_bf16 v[104:107], v[128:131], v[8:11], v[104:107]
    v_mfma_f32_16x16x32_bf16 v[108:111], v[132:135], v[8:11], v[108:111]
    v_mfma_f32_16x16x32_bf16 v[104:107], v[136:139], v[8:11], v[104:107]
    v_mfma_f32_16x16x32_bf16 v[108:111], v[140:143], v[8:11], v[108:111]
    v_mfma_f32_16x16x32_bf16 v[104:107], v[144:147], v[8:11], v[104:107]
    v_mfma_f32_16x16x32_bf16 v[108:111], v[148:151], v[8:11], v[108:111]
    v_mfma_f32_16x16x32_bf16 v[104:107], v[152:155], v[8:11], v[104:107]
    v_mfma_f32_16x16x32_bf16 v[108:111], v[156:159], v[8:11], v[108:111]
    v_mfma_f32_16x16x32_bf16 v[104:107], v[160:163], v[8:11], v[104:107]
    v_mfma_f32_16x16x32_bf16 v[108:111], v[164:167], v[8:11], v[108:111]
    v_mfma_f32_16x16x32_bf16 v[104:107], v[168:171], v[8:11], v[104:107]
    v_mfma_f32_16x16x32_bf16 v[108:111], v[172:175], v[8:11], v[108:111]
    v_mfma_f32_16x16x32_bf16 v[104:107], v[176:179], v[8:11], v[104:107]
    v_mfma_f32_16x16x32_bf16 v[108:111], v[180:183], v[8:11], v[108:111]
    v_mfma_f32_16x16x32_bf16 v[104:107], v[184:187], v[8:11], v[104:107]
    v_mfma_f32_16x16x32_bf16 v[108:111], v[188:191], v[8:11], v[108:111]
    v_mfma_f32_16x16x32_bf16 v[104:107], v[192:195], v[8:11], v[104:107]
    v_mfma_f32_16x16x32_bf16 v[108:111], v[196:199], v[8:11], v[108:111]
    v_mfma_f32_16x16x32_bf16 v[104:107], v[200:203], v[8:11], v[104:107]
    v_mfma_f32_16x16x32_bf16 v[108:111], v[204:207], v[8:11], v[108:111]
    v_mfma_f32_16x16x32_bf16 v[104:107], v[208:211], v[8:11], v[104:107]
    v_mfma_f32_16x16x32_bf16 v[108:111], v[212:215], v[8:11], v[108:111]
    v_mfma_f32_16x16x32_bf16 v[104:107], v[216:219], v[8:11], v[104:107]
    v_mfma_f32_16x16x32_bf16 v[108:111], v[220:223], v[8:11], v[108:111]
    v_mfma_f32_16x16x32_bf16 v[104:107], v[224:227], v[8:11], v[104:107]
    v_mfma_f32_16x16x32_bf16 v[108:111], v[228:231], v[8:11], v[108:111]
    v_mfma_f32_16x16x32_bf16 v[104:107], v[232:235], v[8:11], v[104:107]
    v_mfma_f32_16x16x32_bf16 v[108:111], v[236:239], v[8:11], v[108:111]
    v_mfma_f32_16x16x32_bf16 v[104:107], v[240:243], v[8:11], v[104:107]
    v_mfma_f32_16x16x32_bf16 v[108:111], v[244:247], v[8:11], v[108:111]
    v_mfma_f32_16x16x32_bf16 v[104:107], v[248:251], v[8:11], v[104:107]
    v_mfma_f32_16x16x32_bf16 v[108:111], v[252:255], v[8:11], v[108:111]
    s_mov_b32 s14, 0
    s_nop 6
Lnocs_160:
    s_lshl_b32 s55, s53, 1
    s_add_u32 s55, s55, s54
    s_lshl_b32 s57, s55, 2
    v_lshrrev_b32 v40, 4, v103
    v_and_b32 v41, 15, v103
    v_and_b32 v42, 1, v40
    v_lshlrev_b32 v42, 1, v42
    v_lshrrev_b32 v95, 1, v40
    v_mul_u32_u24 v95, 12, v95
    v_add_u32 v42, v42, v95
    v_xor_b32 v42, v42, v41
    v_lshlrev_b32 v42, 4, v42
    v_lshl_add_u32 v95, v40, 8, v42
    v_add_u32 v96, 38912, v95
    v_lshlrev_b32 v41, 3, v41
    v_lshl_add_u32 v97, v40, 8, v41
    v_add_u32 v97, 16384, v97
    s_cmp_eq_u32 s54, 0
    s_nop 1
    s_cbranch_scc1 Lnoearly_161
    ds_read_b128 v[88:91], v102 offset:16
    s_waitcnt lgkmcnt(0)
    v_min3_u32 v88, v88, v89, v90
    v_min_u32 v88, v88, v91
    s_nop 0
    v_readfirstlane_b32 s68, v88
    s_nop 1
    s_cmp_ge_u32 s68, s55
    s_nop 1
    s_cbranch_scc1 Lnoearly_161
    s_lshl_b32 s62, s50, 4
    s_add_u32 s62, s62, s52
    s_cmp_lg_u32 s94, 0
    s_cbranch_scc1 Lwook_162
    s_lshl_b32 s63, s62, 9
    s_add_u32 s63, s63, 21495808
    v_min_u32 v90, 35, v103
    v_lshlrev_b32 v90, 3, v90
    s_nop 2
Lpn_163:
    buffer_load_dwordx2 v[88:89], v90, s[40:43], s63 offen sc1
    s_waitcnt vmcnt(0)
    v_xor_b32 v88, s58, v88
    v_xor_b32 v89, s59, v89
    v_or_b32 v88, v88, v89
    v_cmp_ne_u32 vcc, 0, v88
    s_nop 1
    s_cmp_eq_u64 vcc, 0
    s_nop 1
    s_cbranch_scc1 Lpnd_164
    s_sub_u32 s56, s56, 1
    s_cmp_eq_u32 s56, 0
    s_mov_b32 s69, 16
    s_cbranch_scc1 L_ABORT
    s_sleep 2
    s_branch Lpn_163
Lpnd_164:
    s_mov_b32 s94, 1
Lwook_162:
    s_mul_i32 s62, s62, 41984
    s_mul_i32 s63, s49, 10240
    s_add_u32 s62, s62, s63
    s_add_u32 s83, s62, 30670848
    s_add_u32 s84, s63, 99584
    v_lshlrev_b32 v92, 4, v103
    s_nop 2
Lwf_165:
    ds_read_b128 v[88:91], v102 offset:80
    s_waitcnt lgkmcnt(0)
    v_min3_u32 v88, v88, v89, v90
    v_min_u32 v88, v88, v91
    s_nop 0
    v_readfirstlane_b32 s68, v88
    s_nop 1
    s_cmp_ge_u32 s68, s53
    s_nop 1
    s_cbranch_scc1 Lwfd_166
    s_sub_u32 s56, s56, 1
    s_cmp_eq_u32 s56, 0
    s_mov_b32 s69, 9
    s_cbranch_scc1 L_ABORT
    s_branch Lwf_165
Lwfd_166:
Lwf_167:
    ds_read_b128 v[88:91], v102 offset:96
    s_waitcnt lgkmcnt(0)
    v_min3_u32 v88, v88, v89, v90
    v_min_u32 v88, v88, v91
    s_nop 0
    v_readfirstlane_b32 s68, v88
    s_nop 1
    s_cmp_ge_u32 s68, s53
    s_nop 1
    s_cbranch_scc1 Lwfd_168
    s_sub_u32 s56, s56, 1
    s_cmp_eq_u32 s56, 0
    s_mov_b32 s69, 14
    s_cbranch_scc1 L_ABORT
    s_branch Lwf_167
Lwfd_168:
    s_add_u32 s60, s83, 0
    s_add_u32 s61, s84, 0
    s_mov_b32 m0, s61
    s_nop 0
    buffer_load_dwordx4 v92, s[40:43], s60 offen offset:0 sc1 lds
    buffer_load_dwordx4 v92, s[40:43], s60 offen offset:1024 sc1 lds
    buffer_load_dwordx4 v92, s[40:43], s60 offen offset:2048 sc1 lds
    buffer_load_dwordx4 v92, s[40:43], s60 offen offset:3072 sc1 lds
    s_add_u32 s60, s83, 4096
    s_add_u32 s61, s84, 4096
    s_mov_b32 m0, s61
    s_nop 0
    buffer_load_dwordx4 v92, s[40:43], s60 offen offset:0 sc1 lds
    buffer_load_dwordx4 v92, s[40:43], s60 offen offset:1024 sc1 lds
    buffer_load_dwordx4 v92, s[40:43], s60 offen offset:2048 sc1 lds
    buffer_load_dwordx4 v92, s[40:43], s60 offen offset:3072 sc1 lds
    s_add_u32 s60, s83, 8192
    s_add_u32 s61, s84, 8192
    s_mov_b32 m0, s61
    s_nop 0
    buffer_load_dwordx4 v92, s[40:43], s60 offen offset:0 sc1 lds
    buffer_load_dwordx4 v92, s[40:43], s60 offen offset:1024 sc1 lds
    s_mov_b32 exec_hi, 0
    buffer_load_dwordx4 v92, s[40:43], s60 offen offset:2048 sc1 lds
    s_mov_b64 exec, -1
    s_mov_b32 s15, 1
Lnoearly_161:
    v_lshlrev_b32 v84, 4, v103
    s_sub_u32 s60, s53, 1
    s_mul_i32 s60, s60, 0
    s_add_u32 s60, s60, 9437184
    s_mul_i32 s61, s54, 77824
    s_add_u32 s60, s60, s61
    s_add_u32 s83, s60, s95
    s_sub_u32 s83, s83, s4
    s_mul_i32 s84, s49, 4864
    s_add_u32 s83, s83, s84
    s_setprio 0
Lwf_169:
    ds_read_b128 v[88:91], v102 offset:16
    s_waitcnt lgkmcnt(0)
    v_min3_u32 v88, v88, v89, v90
    v_min_u32 v88, v88, v91
    s_nop 0
    v_readfirstlane_b32 s68, v88
    s_nop 1
    s_cmp_ge_u32 s68, s55
    s_nop 1
    s_cbranch_scc1 Lwfd_170
    s_sub_u32 s56, s56, 1
    s_cmp_eq_u32 s56, 0
    s_mov_b32 s69, 6
    s_cbranch_scc1 L_ABORT
    s_sleep 1
    s_branch Lwf_169
Lwfd_170:
    v_lshlrev_b32 v90, 3, v103
    s_lshl_b32 s62, s54, 9
    s_add_u32 s62, s62, s12
    s_lshl_b32 s63, s49, 7
    s_sub_u32 s62, s62, s63
    s_add_u32 s62, s62, 1024
    s_add_u32 s63, s58, s53
    s_mov_b64 vcc, -1
Lsp_171:
    s_and_b32 s60, vcc_hi, 0xffff0000
    s_cbranch_scc0 Lsg_172
    buffer_load_dwordx2 v[88:89], v90, s[40:43], s62 offen sc1
    s_sub_u32 s56, s56, 1
    s_cmp_eq_u32 s56, 0
    s_mov_b32 s69, 12
    s_cbranch_scc1 L_ABORT
    s_waitcnt vmcnt(0)
    v_subrev_u32 v88, s63, v88
    v_xor_b32 v89, s59, v89
    v_lshrrev_b32 v88, 3, v88
    v_or_b32 v88, v88, v89
    v_cmp_ne_u32 vcc, 0, v88
    s_nop 4
    s_branch Lsp_171
Lsg_172:
    s_add_u32 s60, s83, 58368
    s_add_u32 s61, s84, 58368
    s_mov_b32 m0, s61
    s_nop 0
    buffer_load_dwordx4 v84, s[40:43], s60 offen offset:0 sc1 lds
    buffer_load_dwordx4 v84, s[40:43], s60 offen offset:1024 sc1 lds
    buffer_load_dwordx4 v84, s[40:43], s60 offen offset:2048 sc1 lds
    buffer_load_dwordx4 v84, s[40:43], s60 offen offset:3072 sc1 lds
    s_add_u32 s60, s60, 4096
    s_add_u32 s61, s61, 4096
    s_mov_b32 m0, s61
    s_mov_b32 exec_hi, 0xffff
    buffer_load_dwordx4 v84, s[40:43], s60 offen sc1 lds
    s_mov_b32 exec_hi, -1
Lsp_173:
    s_and_b32 s60, vcc_lo, 0xffff0000
    s_cbranch_scc0 Lsg_174
    buffer_load_dwordx2 v[88:89], v90, s[40:43], s62 offen sc1
    s_sub_u32 s56, s56, 1
    s_cmp_eq_u32 s56, 0
    s_mov_b32 s69, 12
    s_cbranch_scc1 L_ABORT
    s_waitcnt vmcnt(0)
    v_subrev_u32 v88, s63, v88
    v_xor_b32 v89, s59, v89
    v_lshrrev_b32 v88, 3, v88
    v_or_b32 v88, v88, v89
    v_cmp_ne_u32 vcc, 0, v88
    s_nop 4
    s_branch Lsp_173
Lsg_174:
    s_add_u32 s60, s83, 19456
    s_add_u32 s61, s84, 19456
    s_mov_b32 m0, s61
    s_nop 0
    buffer_load_dwordx4 v84, s[40:43], s60 offen offset:0 sc1 lds
    buffer_load_dwordx4 v84, s[40:43], s60 offen offset:1024 sc1 lds
    buffer_load_dwordx4 v84, s[40:43], s60 offen offset:2048 sc1 lds
    buffer_load_dwordx4 v84, s[40:43], s60 offen offset:3072 sc1 lds
    s_add_u32 s60, s60, 4096
    s_add_u32 s61, s61, 4096
    s_mov_b32 m0, s61
    s_mov_b32 exec_hi, 0xffff
    buffer_load_dwordx4 v84, s[40:43], s60 offen sc1 lds
    s_mov_b32 exec_hi, -1
Lsp_175:
    s_and_b32 s60, vcc_hi, 0xffff
    s_cbranch_scc0 Lsg_176
    buffer_load_dwordx2 v[88:89], v90, s[40:43], s62 offen sc1
    s_sub_u32 s56, s56, 1
    s_cmp_eq_u32 s56, 0
    s_mov_b32 s69, 12
    s_cbranch_scc1 L_ABORT
    s_waitcnt vmcnt(0)
    v_subrev_u32 v88, s63, v88
    v_xor_b32 v89, s59, v89
    v_lshrrev_b32 v88, 3, v88
    v_or_b32 v88, v88, v89
    v_cmp_ne_u32 vcc, 0, v88
    s_nop 4
    s_branch Lsp_175
Lsg_176:
    s_add_u32 s60, s83, 38912
    s_add_u32 s61, s84, 38912
    s_mov_b32 m0, s61
    s_nop 0
    buffer_load_dwordx4 v84, s[40:43], s60 offen offset:0 sc1 lds
    buffer_load_dwordx4 v84, s[40:43], s60 offen offset:1024 sc1 lds
    buffer_load_dwordx4 v84, s[40:43], s60 offen offset:2048 sc1 lds
    buffer_load_dwordx4 v84, s[40:43], s60 offen offset:3072 sc1 lds
    s_add_u32 s60, s60, 4096
    s_add_u32 s61, s61, 4096
    s_mov_b32 m0, s61
    s_mov_b32 exec_hi, 0xffff
    buffer_load_dwordx4 v84, s[40:43], s60 offen sc1 lds
    s_mov_b32 exec_hi, -1
Lsp_177:
    s_and_b32 s60, vcc_lo, 0xffff
    s_cbranch_scc0 Lsg_178
    buffer_load_dwordx2 v[88:89], v90, s[40:43], s62 offen sc1
    s_sub_u32 s56, s56, 1
    s_cmp_eq_u32 s56, 0
    s_mov_b32 s69, 12
    s_cbranch_scc1 L_ABORT
    s_waitcnt vmcnt(0)
    v_subrev_u32 v88, s63, v88
    v_xor_b32 v89, s59, v89
    v_lshrrev_b32 v88, 3, v88
    v_or_b32 v88, v88, v89
    v_cmp_ne_u32 vcc, 0, v88
    s_nop 4
    s_branch Lsp_177
Lsg_178:
    s_add_u32 s60, s83, 0
    s_add_u32 s61, s84, 0
    s_mov_b32 m0, s61
    s_nop 0
    buffer_load_dwordx4 v84, s[40:43], s60 offen offset:0 sc1 lds
    buffer_load_dwordx4 v84, s[40:43], s60 offen offset:1024 sc1 lds
    buffer_load_dwordx4 v84, s[40:43], s60 offen offset:2048 sc1 lds
    buffer_load_dwordx4 v84, s[40:43], s60 offen offset:3072 sc1 lds
    s_add_u32 s60, s60, 4096
    s_add_u32 s61, s61, 4096
    s_mov_b32 m0, s61
    s_mov_b32 exec_hi, 0xffff
    buffer_load_dwordx4 v84, s[40:43], s60 offen sc1 lds
    s_mov_b32 exec_hi, -1
    s_mov_b32 s13, 1
    s_cmp_eq_u32 s54, 0
    s_cbranch_scc1 L_M_GO
    s_mov_b32 s13, 0
    s_waitcnt vmcnt(10)
    s_lshl_b32 s68, s49, 2
    v_add_u32 v88, s68, v102
    s_add_u32 s68, s57, 2
    v_mov_b32 v89, s68
    ds_write_b32 v88, v89 offset:0
    s_cmp_lg_u32 s15, 0
    s_nop 0
    s_cbranch_scc1 Lwe_179
    s_lshl_b32 s62, s50, 4
    s_add_u32 s62, s62, s52
    s_cmp_lg_u32 s94, 0
    s_cbranch_scc1 Lwook_181
    s_lshl_b32 s63, s62, 9
    s_add_u32 s63, s63, 21495808
    v_min_u32 v90, 35, v103
    v_lshlrev_b32 v90, 3, v90
    s_nop 2
Lpn_182:
    buffer_load_dwordx2 v[88:89], v90, s[40:43], s63 offen sc1
    s_waitcnt vmcnt(0)
    v_xor_b32 v88, s58, v88
    v_xor_b32 v89, s59, v89
    v_or_b32 v88, v88, v89
    v_cmp_ne_u32 vcc, 0, v88
    s_nop 1
    s_cmp_eq_u64 vcc, 0
    s_nop 1
    s_cbranch_scc1 Lpnd_183
    s_sub_u32 s56, s56, 1
    s_cmp_eq_u32 s56, 0
    s_mov_b32 s69, 16
    s_cbranch_scc1 L_ABORT
    s_sleep 2
    s_branch Lpn_182
Lpnd_183:
    s_mov_b32 s94, 1
Lwook_181:
    s_mul_i32 s62, s62, 41984
    s_mul_i32 s63, s49, 10240
    s_add_u32 s62, s62, s63
    s_add_u32 s83, s62, 30670848
    s_add_u32 s84, s63, 99584
    v_lshlrev_b32 v92, 4, v103
    s_nop 2
Lwf_184:
    ds_read_b128 v[88:91], v102 offset:80
    s_waitcnt lgkmcnt(0)
    v_min3_u32 v88, v88, v89, v90
    v_min_u32 v88, v88, v91
    s_nop 0
    v_readfirstlane_b32 s68, v88
    s_nop 1
    s_cmp_ge_u32 s68, s53
    s_nop 1
    s_cbranch_scc1 Lwfd_185
    s_sub_u32 s56, s56, 1
    s_cmp_eq_u32 s56, 0
    s_mov_b32 s69, 9
    s_cbranch_scc1 L_ABORT
    s_branch Lwf_184
Lwfd_185:
Lwf_186:
    ds_read_b128 v[88:91], v102 offset:96
    s_waitcnt lgkmcnt(0)
    v_min3_u32 v88, v88, v89, v90
    v_min_u32 v88, v88, v91
    s_nop 0
    v_readfirstlane_b32 s68, v88
    s_nop 1
    s_cmp_ge_u32 s68, s53
    s_nop 1
    s_cbranch_scc1 Lwfd_187
    s_sub_u32 s56, s56, 1
    s_cmp_eq_u32 s56, 0
    s_mov_b32 s69, 14
    s_cbranch_scc1 L_ABORT
    s_branch Lwf_186
Lwfd_187:
    s_add_u32 s60, s83, 0
    s_add_u32 s61, s84, 0
    s_mov_b32 m0, s61
    s_nop 0
    buffer_load_dwordx4 v92, s[40:43], s60 offen offset:0 sc1 lds
    buffer_load_dwordx4 v92, s[40:43], s60 offen offset:1024 sc1 lds
    buffer_load_dwordx4 v92, s[40:43], s60 offen offset:2048 sc1 lds
    buffer_load_dwordx4 v92, s[40:43], s60 offen offset:3072 sc1 lds
    s_add_u32 s60, s83, 4096
    s_add_u32 s61, s84, 4096
    s_mov_b32 m0, s61
    s_nop 0
    buffer_load_dwordx4 v92, s[40:43], s60 offen offset:0 sc1 lds
    buffer_load_dwordx4 v92, s[40:43], s60 offen offset:1024 sc1 lds
    buffer_load_dwordx4 v92, s[40:43], s60 offen offset:2048 sc1 lds
    buffer_load_dwordx4 v92, s[40:43], s60 offen offset:3072 sc1 lds
    s_add_u32 s60, s83, 8192
    s_add_u32 s61, s84, 8192
    s_mov_b32 m0, s61
    s_nop 0
    buffer_load_dwordx4 v92, s[40:43], s60 offen offset:0 sc1 lds
    buffer_load_dwordx4 v92, s[40:43], s60 offen offset:1024 sc1 lds
    s_mov_b32 exec_hi, 0
    buffer_load_dwordx4 v92, s[40:43], s60 offen offset:2048 sc1 lds
    s_mov_b64 exec, -1
    s_waitcnt vmcnt(11)
    s_branch Lwf_180
Lwe_179:
    s_waitcnt vmcnt(0)
Lwf_180:
    s_lshl_b32 s68, s49, 2
    v_add_u32 v88, s68, v102
    s_add_u32 s68, s57, 4
    v_mov_b32 v89, s68
    ds_write_b32 v88, v89 offset:0
    s_mov_b32 s15, 1
    s_cmp_eq_u32 s54, 0
    s_cbranch_scc1 L_M_ROLE
    s_mov_b32 s54, 0
    s_branch L_BPHASE
L_ABORT:
    s_mov_b64 exec, -1
    s_lshl_b32 s60, s69, 2
    s_add_u32 s60, s60, 64
    v_mov_b32 v0, s2
    v_add_u32 v0, 0x1000, v0
    v_mov_b32 v1, s60
    buffer_store_dword v0, v1, s[44:47], 0 offen sc1
    s_nop 1
L_END:
    s_endpgm
.section .rodata,"a"
.p2align 6
.amdhsa_kernel interleave_layers__sliding_local_dilated__sliding_local_dilated__prompt_kernel
  .amdhsa_next_free_vgpr 256
  .amdhsa_next_free_sgpr 96
  .amdhsa_accum_offset 256
  .amdhsa_group_segment_fixed_size 0
  .amdhsa_kernarg_size 72
  .amdhsa_user_sgpr_count 2
  .amdhsa_user_sgpr_kernarg_segment_ptr 1
  .amdhsa_system_sgpr_workgroup_id_x 1
.end_amdhsa_kernel
```
